```python
import torch

def _softmax(x, axis=-1):
    return torch.softmax(x, dim=axis)
def _gelu(x):
    return torch.nn.functional.gelu(x, approximate="tanh")
def _silu(x):
    return torch.nn.functional.silu(x)
def _sigmoid(x):
    return torch.sigmoid(x)
def _layernorm(x, axis=-1, eps=1e-5):
    m = x.mean(dim=axis, keepdim=True)
    v = x.var(dim=axis, keepdim=True, unbiased=False)
    return (x - m) / torch.sqrt(v + eps)
def _scatter_add(tgt, idx, src, axis=0):
    return tgt.clone().index_add_(axis, idx, src)
def _segment_sum(src, seg, n):
    out = torch.zeros((n,) + src.shape[1:], dtype=src.dtype)
    return out.index_add_(0, seg, src)
def _pad(x, pw):
    flat = tuple(v for pair in reversed(pw) for v in pair)
    return torch.nn.functional.pad(x, flat)

kernel_name = 'concat_heads__ssm_conv_s4d__ssm_conv_s4d__prompt'

def setup_inputs():

    _w = (lambda a: (lambda t: t.to(torch.bfloat16) if t.is_floating_point() else t)(torch.as_tensor(a)))
    def _A_setup():
        Bsz, L, D, N = 1, 2048, 576, 128
        return {
            "u": _w((lambda *s: torch.randn(*s, dtype=torch.bfloat16) * 0.05)(Bsz, L, D)),
            "log_A_real": _w((lambda *s: torch.randn(*s, dtype=torch.bfloat16) * 6.4)(D, N) * 0.5),
            "A_imag": _w((lambda *s: torch.randn(*s, dtype=torch.bfloat16) * 0.05)(D, N) * 3.14),
            "C_real": _w((lambda *s: torch.randn(*s, dtype=torch.bfloat16) * 0.05)(D, N) / N ** 0.5),
            "C_imag": _w((lambda *s: torch.randn(*s, dtype=torch.bfloat16) * 0.05)(D, N) / N ** 0.5),
            "log_dt": _w((lambda *s: torch.randn(*s, dtype=torch.bfloat16) * 0.05)(D) * 0.5 - 4.0),
            "D_skip": _w((lambda *s: torch.randn(*s, dtype=torch.bfloat16) * 0.05)(D)),
        }
    _A_in = _A_setup()

    def _B_setup():
        Bsz, L, D, N = 1, 2048, 576, 128
        return {
            "u": _w((lambda *s: torch.randn(*s, dtype=torch.bfloat16) * 0.05)(Bsz, L, D)),
            "log_A_real": _w((lambda *s: torch.randn(*s, dtype=torch.bfloat16) * 6.4)(D, N) * 0.5),
            "A_imag": _w((lambda *s: torch.randn(*s, dtype=torch.bfloat16) * 0.05)(D, N) * 3.14),
            "C_real": _w((lambda *s: torch.randn(*s, dtype=torch.bfloat16) * 0.05)(D, N) / N ** 0.5),
            "C_imag": _w((lambda *s: torch.randn(*s, dtype=torch.bfloat16) * 0.05)(D, N) / N ** 0.5),
            "log_dt": _w((lambda *s: torch.randn(*s, dtype=torch.bfloat16) * 0.05)(D) * 0.5 - 4.0),
            "D_skip": _w((lambda *s: torch.randn(*s, dtype=torch.bfloat16) * 0.05)(D)),
        }
    _B_in = _B_setup()

    return {
        "A_u": _A_in["u"],
        "A_log_A_real": _A_in["log_A_real"],
        "A_A_imag": _A_in["A_imag"],
        "A_C_real": _A_in["C_real"],
        "A_C_imag": _A_in["C_imag"],
        "A_log_dt": _A_in["log_dt"],
        "A_D_skip": _A_in["D_skip"],
        "B_u": _B_in["u"],
        "B_log_A_real": _B_in["log_A_real"],
        "B_A_imag": _B_in["A_imag"],
        "B_C_real": _B_in["C_real"],
        "B_C_imag": _B_in["C_imag"],
        "B_log_dt": _B_in["log_dt"],
        "B_D_skip": _B_in["D_skip"],
    }

def reference(A_u, A_log_A_real, A_A_imag, A_C_real, A_C_imag, A_log_dt, A_D_skip, B_u, B_log_A_real, B_A_imag, B_C_real, B_C_imag, B_log_dt, B_D_skip):
    def _A_ref(u, log_A_real, A_imag, C_real, C_imag, log_dt, D_skip):
        L = u.shape[1]
        dt = torch.exp(log_dt)
        A = -torch.exp(log_A_real) + 1j * A_imag
        C = (C_real + 1j * C_imag) * dt[:, None]
        pos = (lambda x, dt: x.to(dt))(torch.arange(L), log_dt.dtype)
        P = torch.exp((A * dt[:, None])[:, :, None] * pos[None, None, :])
        K = 2.0 * torch.einsum("dn,dnl->dl", C, P).real
        L2 = 2 * L
        u_t = (lambda x, *d: x.permute(*d))(u, 0, 2, 1)
        Kf = (lambda x, *a, **k: torch.fft.rfft(x.float(), *a, **k))(K, L2)
        Uf = (lambda x, *a, **k: torch.fft.rfft(x.float(), *a, **k))(u_t, L2)
        y = (lambda x, *a, **k: torch.fft.irfft(x, *a, **k).to(torch.bfloat16))(Uf * Kf[None, :, :], L2)[:, :, :L]
        y = (lambda x, *d: x.permute(*d))(y, 0, 2, 1)
        return y + u * D_skip[None, None, :]

    def _B_ref(u, log_A_real, A_imag, C_real, C_imag, log_dt, D_skip):
        L = u.shape[1]
        dt = torch.exp(log_dt)
        A = -torch.exp(log_A_real) + 1j * A_imag
        C = (C_real + 1j * C_imag) * dt[:, None]
        pos = (lambda x, dt: x.to(dt))(torch.arange(L), log_dt.dtype)
        P = torch.exp((A * dt[:, None])[:, :, None] * pos[None, None, :])
        K = 2.0 * torch.einsum("dn,dnl->dl", C, P).real
        L2 = 2 * L
        u_t = (lambda x, *d: x.permute(*d))(u, 0, 2, 1)
        Kf = (lambda x, *a, **k: torch.fft.rfft(x.float(), *a, **k))(K, L2)
        Uf = (lambda x, *a, **k: torch.fft.rfft(x.float(), *a, **k))(u_t, L2)
        y = (lambda x, *a, **k: torch.fft.irfft(x, *a, **k).to(torch.bfloat16))(Uf * Kf[None, :, :], L2)[:, :, :L]
        y = (lambda x, *d: x.permute(*d))(y, 0, 2, 1)
        return y + u * D_skip[None, None, :]

    a = _A_ref(A_u, A_log_A_real, A_A_imag, A_C_real, A_C_imag, A_log_dt, A_D_skip)
    b = _B_ref(B_u, B_log_A_real, B_A_imag, B_C_real, B_C_imag, B_log_dt, B_D_skip)
    return torch.concatenate([a, b], axis=-1)
```

```asm
; @launch grid=(216,1,1) block=(1024,1,1) lds=152064
.amdgcn_target "amdgcn-amd-amdhsa--gfx950"
.text
.globl concat_heads__ssm_conv_s4d__ssm_conv_s4d__prompt_kernel
.p2align 8
.type concat_heads__ssm_conv_s4d__ssm_conv_s4d__prompt_kernel,@function
concat_heads__ssm_conv_s4d__ssm_conv_s4d__prompt_kernel:
    s_bitcmp1_b32 s2, 2
    s_cselect_b32 s6, 56, 0
    s_load_dwordx16 s[16:31], s[0:1], s6
    v_lshrrev_b32 v2, 6, v0
    s_and_b32 s3, s2, 3
    s_mul_i32 s3, s3, 27
    v_readfirstlane_b32 s44, v2
    s_lshr_b32 s4, s2, 3
    s_cmp_ge_u32 s4, 27
    s_cbranch_scc1 L_end
    s_add_u32 s3, s3, s4
    v_and_b32 v1, 63, v0
    s_mul_i32 s4, s3, 43
    s_lshr_b32 s4, s4, 8
    s_mul_i32 s5, s4, 6
    s_sub_u32 s5, s3, s5
    s_cmp_ge_u32 s5, 4
    s_cselect_b32 s43, 3, 5
    s_lshl2_add_u32 s7, s5, 8
    s_mul_i32 s5, s5, 6
    s_min_u32 s5, s5, s7
    s_lshl_b32 s4, s4, 5
    s_add_u32 s5, s5, s4
    s_cmp_lt_u32 s44, 4
    s_cbranch_scc1 L_mem0
    s_cmp_ge_u32 s44, 10
    s_cselect_b32 s62, 1, 0
    s_cselect_b32 s45, 10, 4
    s_sub_u32 s45, s44, s45
    s_cmp_ge_u32 s44, 12
    s_cbranch_scc1 L_tdis
L_tback:
    s_cmp_gt_u32 s45, s43
    s_cbranch_scc1 L_end
    s_add_u32 s46, s5, s45
    s_lshl_b32 s8, s46, 8
    v_lshl_add_u32 v20, v1, 2, s8
    s_waitcnt lgkmcnt(0)
    global_load_dword v36, v20, s[18:19]
    global_load_dword v37, v20, s[20:21]
    global_load_dword v38, v20, s[22:23]
    global_load_dword v39, v20, s[24:25]
    s_lshl_b32 s8, s46, 1
    s_and_b32 s8, s8, -4
    s_load_dword s40, s[26:27], s8
    s_load_dword s41, s[28:29], s8
    s_setprio 3
    s_branch L_tskip
L_tdis:
    s_mov_b64 exec, 0
    s_cmp_eq_u32 s44, 12
    s_cbranch_scc1 L_t0
    s_cmp_eq_u32 s44, 13
    s_cbranch_scc1 L_t1
    s_cmp_eq_u32 s44, 14
    s_cbranch_scc1 L_t2
    s_branch L_t3
L_tret:
    s_mov_b64 exec, -1
    s_branch L_tback
L_tskip:
    s_mul_i32 s61, s45, 10752
    s_mul_i32 s60, s62, 4896
    s_add_u32 s60, s60, s61
    s_mov_b32 m0, s60
    s_movk_i32 s9, 288
    s_mov_b32 s10, 0x76543210
    s_mov_b32 s11, 0xfebbba88
    v_and_b32 v20, 15, v1
    v_and_b32 v21, 48, v1
    v_add_u32 v24, s60, v21
    v_mad_u32_u24 v7, v20, s9, v24
    v_add_u32 v9, 4608, v24
    v_lshlrev_b32 v25, 2, v20
    v_lshrrev_b64 v[26:27], v25, s[10:11]
    v_and_b32 v26, 15, v26
    v_mad_u32_u24 v8, v26, s9, v24
    v_lshlrev_b32 v15, 4, v1
    v_add_u32 v15, 147968, v15
    s_mov_b32 s49, 0x01000c0c
    s_cmp_lg_u32 s62, 0
    s_cselect_b32 s49, 0x03020c0c, s49
    s_mov_b32 s12, 0xbfb8aa3b
    s_mov_b32 s13, 0x3e22f983
    s_mov_b32 s14, 0x41000000
    s_mov_b32 s15, 0x43800000
    s_mov_b32 s63, 0x3fb8aa3b
    s_mov_b32 s35, 0x7fff7fff
    s_mov_b32 s34, 0x40000
    v_mov_b32 v2, 1
    s_mul_i32 s57, s45, 8448
L_t0:
    s_cbranch_execz L_tret
    s_add_u32 s57, s57, 65536
    s_mul_i32 s56, s45, 4608
    s_add_u32 s56, s56, 116224
    s_lshl_b32 s8, s45, 7
    s_add_u32 s8, s8, 64512
    v_mov_b32 v1, s8
    s_lshl_b32 s8, s62, 10
    v_add_u32 v14, s8, v15
    s_barrier
    s_waitcnt lgkmcnt(0)
    s_lshl_b32 s8, s40, 16
    s_and_b32 s40, s40, 0xffff0000
    s_lshl_b32 s9, s41, 16
    s_and_b32 s41, s41, 0xffff0000
    s_bitcmp0_b32 s46, 0
    s_cselect_b32 s40, s8, s40
    s_cselect_b32 s41, s9, s41
    v_mov_b32 v84, s63
    v_mov_b32 v85, 0
    v_mul_f32 v84, s40, v84
    v_writelane_b32 v85, s41, 0
    v_exp_f32 v84, v84
    s_waitcnt vmcnt(0)
    v_perm_b32 v56, v36, v36, s49
L_t1:
    s_cbranch_execz L_tret
    v_and_b32 v70, s35, v38
    v_mul_f32 v56, s63, v56
    v_and_b32 v71, s35, v39
    v_exp_f32 v56, v56
    v_pk_max_u16 v70, v70, v71
    v_perm_b32 v57, v37, v37, s49
    v_lshlrev_b32 v71, 16, v70
    v_cvt_pk_bf16_f32 v84, v84, v56
    v_max_u32 v70, v70, v71
    v_and_b32 v56, 0xffff0000, v84
    v_lshlrev_b32 v84, 16, v84
    v_max_u32_dpp v70, v70, v70 row_shr:1 row_mask:0xf bank_mask:0xf
    v_pk_mul_f32 v[52:53], v[56:57], v[84:85] op_sel_hi:[1,0]
    v_pk_mul_f32 v[52:53], v[52:53], s[12:13]
    v_max_u32_dpp v70, v70, v70 row_shr:2 row_mask:0xf bank_mask:0xf
    v_pk_mul_f32 v[56:57], v[52:53], s[14:15] op_sel_hi:[1,0]
    v_pk_mul_f32 v[58:59], v[52:53], s[14:15] op_sel:[0,1] op_sel_hi:[1,1]
    v_max_u32_dpp v70, v70, v70 row_shr:4 row_mask:0xf bank_mask:0xf
    v_fract_f32 v53, v53
    v_exp_f32 v52, v52
    v_max_u32_dpp v70, v70, v70 row_shr:8 row_mask:0xf bank_mask:0xf
    v_cos_f32 v60, v53
    v_sin_f32 v61, v53
    v_max_u32_dpp v70, v70, v70 row_bcast:15 row_mask:0xa bank_mask:0xf
L_t2:
    s_cbranch_execz L_tret
    v_fract_f32 v59, v59
    v_pk_mul_f32 v[60:61], v[60:61], v[52:53] op_sel_hi:[1,0]
    v_max_u32_dpp v70, v70, v70 row_bcast:31 row_mask:0xc bank_mask:0xf
    v_exp_f32 v58, v58
    v_cos_f32 v64, v59
    v_readlane_b32 s10, v70, 63
    v_sin_f32 v65, v59
    v_fract_f32 v57, v57
    v_perm_b32 v54, v38, v38, s49
    s_and_b32 s10, s10, 0x7f800000
    s_sub_u32 s8, 0x7f000000, s10
    s_add_u32 s10, s10, 0x00800000
    v_pk_mul_f32 v[64:65], v[64:65], v[58:59] op_sel_hi:[1,0]
    v_perm_b32 v55, v39, v39, s49
    v_exp_f32 v56, v56
    v_cos_f32 v62, v57
    v_sin_f32_e64 v63, -v57
    v_pk_mul_f32 v[54:55], v[54:55], s[8:9] op_sel_hi:[1,0]
    v_cvt_pk_f16_f32 v88, v60, v61
    v_pk_mul_f32 v[62:63], v[62:63], v[56:57] op_sel_hi:[1,0]
    v_cvt_pk_f16_f32 v91, v64, v65
    v_mul_f32 v86, s10, v84
    v_cvt_pk_f16_f32 v111, v54, v55
    v_pk_mul_f16 v89, v88, v88 op_sel:[0,0] op_sel_hi:[0,1]
L_t3:
    s_cbranch_execz L_tret
    v_pk_fma_f16 v89, v88, v88, v89 op_sel:[1,1,0] op_sel_hi:[1,0,1] neg_lo:[0,1,0]
    v_cvt_pk_f16_f32 v95, v62, v63
    v_pk_mul_f16 v120, v111, v88 op_sel:[0,0] op_sel_hi:[0,1]
    v_pk_fma_f16 v120, v111, v88, v120 op_sel:[1,1,0] op_sel_hi:[1,0,1] neg_lo:[0,1,0]
    v_pk_mul_f16 v112, v111, v89 op_sel:[0,0] op_sel_hi:[0,1]
    v_pk_fma_f16 v112, v111, v89, v112 op_sel:[1,1,0] op_sel_hi:[1,0,1] neg_lo:[0,1,0]
    v_pk_mul_f16 v121, v112, v88 op_sel:[0,0] op_sel_hi:[0,1]
    v_pk_fma_f16 v121, v112, v88, v121 op_sel:[1,1,0] op_sel_hi:[1,0,1] neg_lo:[0,1,0]
    v_pk_mul_f16 v113, v112, v89 op_sel:[0,0] op_sel_hi:[0,1]
    v_pk_fma_f16 v113, v112, v89, v113 op_sel:[1,1,0] op_sel_hi:[1,0,1] neg_lo:[0,1,0]
    v_pk_mul_f16 v122, v113, v88 op_sel:[0,0] op_sel_hi:[0,1]
    v_pk_fma_f16 v122, v113, v88, v122 op_sel:[1,1,0] op_sel_hi:[1,0,1] neg_lo:[0,1,0]
    v_pk_mul_f16 v114, v113, v89 op_sel:[0,0] op_sel_hi:[0,1]
    v_pk_fma_f16 v114, v113, v89, v114 op_sel:[1,1,0] op_sel_hi:[1,0,1] neg_lo:[0,1,0]
    v_pk_mul_f16 v123, v114, v88 op_sel:[0,0] op_sel_hi:[0,1]
    v_pk_fma_f16 v123, v114, v88, v123 op_sel:[1,1,0] op_sel_hi:[1,0,1] neg_lo:[0,1,0]
    ds_write_addtid_b32 v111 offset:0
    ds_write_addtid_b32 v120 offset:288
    ds_write_addtid_b32 v112 offset:576
    ds_write_addtid_b32 v121 offset:864
    ds_write_addtid_b32 v113 offset:1152
    ds_write_addtid_b32 v122 offset:1440
    ds_write_addtid_b32 v114 offset:1728
    ds_write_addtid_b32 v123 offset:2016
    v_pk_mul_f16 v115, v111, v91 op_sel:[0,0] op_sel_hi:[0,1]
    v_pk_fma_f16 v115, v111, v91, v115 op_sel:[1,1,0] op_sel_hi:[1,0,1] neg_lo:[0,1,0]
    v_pk_mul_f16 v124, v112, v91 op_sel:[0,0] op_sel_hi:[0,1]
    v_pk_fma_f16 v124, v112, v91, v124 op_sel:[1,1,0] op_sel_hi:[1,0,1] neg_lo:[0,1,0]
    v_pk_mul_f16 v116, v113, v91 op_sel:[0,0] op_sel_hi:[0,1]
    v_pk_fma_f16 v116, v113, v91, v116 op_sel:[1,1,0] op_sel_hi:[1,0,1] neg_lo:[0,1,0]
    v_pk_mul_f16 v125, v114, v91 op_sel:[0,0] op_sel_hi:[0,1]
    v_pk_fma_f16 v125, v114, v91, v125 op_sel:[1,1,0] op_sel_hi:[1,0,1] neg_lo:[0,1,0]
    v_pk_mul_f16 v126, v115, v95 op_sel:[0,0] op_sel_hi:[0,1] neg_hi:[0,1]
    v_pk_fma_f16 v126, v115, v95, v126 op_sel:[1,1,0] op_sel_hi:[1,0,1]
    ds_write_addtid_b32 v115 offset:2304
    ds_write_addtid_b32 v124 offset:2880
    ds_write_addtid_b32 v116 offset:3168
    ds_write_addtid_b32 v125 offset:4032
    ds_write_addtid_b32 v126 offset:4320
    ds_read_b128 v[20:23], v8 offset:0
    ds_read_b128 v[24:27], v8 offset:64
    ds_read_b128 v[28:31], v8 offset:128
    ds_read_b128 v[32:35], v8 offset:192
    v_pk_mul_f16 v92, v91, v91 op_sel:[0,0] op_sel_hi:[0,1]
    v_pk_fma_f16 v92, v91, v91, v92 op_sel:[1,1,0] op_sel_hi:[1,0,1] neg_lo:[0,1,0]
    v_pk_mul_f32 v[66:67], v[62:63], v[62:63] op_sel:[0,0] op_sel_hi:[0,1]
    v_pk_fma_f32 v[66:67], v[62:63], v[62:63], v[66:67] op_sel:[1,1,0] op_sel_hi:[1,0,1] neg_lo:[0,1,0]
    v_pk_mul_f16 v117, v111, v92 op_sel:[0,0] op_sel_hi:[0,1]
    v_pk_fma_f16 v117, v111, v92, v117 op_sel:[1,1,0] op_sel_hi:[1,0,1] neg_lo:[0,1,0]
    v_pk_mul_f16 v127, v113, v92 op_sel:[0,0] op_sel_hi:[0,1]
    v_pk_fma_f16 v127, v113, v92, v127 op_sel:[1,1,0] op_sel_hi:[1,0,1] neg_lo:[0,1,0]
    v_pk_mul_f16 v118, v115, v92 op_sel:[0,0] op_sel_hi:[0,1]
    v_pk_fma_f16 v118, v115, v92, v118 op_sel:[1,1,0] op_sel_hi:[1,0,1] neg_lo:[0,1,0]
    v_pk_mul_f16 v120, v116, v92 op_sel:[0,0] op_sel_hi:[0,1]
    v_pk_fma_f16 v120, v116, v92, v120 op_sel:[1,1,0] op_sel_hi:[1,0,1] neg_lo:[0,1,0]
    v_pk_mul_f32 v[68:69], v[66:67], v[66:67] op_sel:[0,0] op_sel_hi:[0,1]
    v_pk_fma_f32 v[68:69], v[66:67], v[66:67], v[68:69] op_sel:[1,1,0] op_sel_hi:[1,0,1] neg_lo:[0,1,0]
    v_pk_mul_f16 v119, v117, v92 op_sel:[0,0] op_sel_hi:[0,1]
    v_pk_fma_f16 v119, v117, v92, v119 op_sel:[1,1,0] op_sel_hi:[1,0,1] neg_lo:[0,1,0]
    v_pk_mul_f16 v112, v118, v92 op_sel:[0,0] op_sel_hi:[0,1]
    v_pk_fma_f16 v112, v118, v92, v112 op_sel:[1,1,0] op_sel_hi:[1,0,1] neg_lo:[0,1,0]
    v_pk_mul_f16 v114, v119, v92 op_sel:[0,0] op_sel_hi:[0,1]
    v_pk_fma_f16 v114, v119, v92, v114 op_sel:[1,1,0] op_sel_hi:[1,0,1] neg_lo:[0,1,0]
    v_pk_mul_f16 v121, v112, v92 op_sel:[0,0] op_sel_hi:[0,1]
    v_pk_fma_f16 v121, v112, v92, v121 op_sel:[1,1,0] op_sel_hi:[1,0,1] neg_lo:[0,1,0]
    ds_write_addtid_b32 v117 offset:0
    ds_write_addtid_b32 v127 offset:288
    ds_write_addtid_b32 v118 offset:1152
    ds_write_addtid_b32 v120 offset:1440
    ds_write_addtid_b32 v119 offset:2304
    ds_write_addtid_b32 v112 offset:3456
    ds_write_addtid_b32 v114 offset:2592
    ds_write_addtid_b32 v121 offset:3744
    v_pk_mul_f16 v122, v114, v92 op_sel:[0,0] op_sel_hi:[0,1]
    v_pk_fma_f16 v122, v114, v92, v122 op_sel:[1,1,0] op_sel_hi:[1,0,1] neg_lo:[0,1,0]
    ds_write_addtid_b32 v122 offset:1728
    ds_read_b128 v[36:39], v7 offset:0
    ds_read_b128 v[40:43], v7 offset:64
    ds_read_b128 v[44:47], v7 offset:128
    ds_read_b128 v[48:51], v7 offset:192
    s_setprio 2
    v_mov_b32 v123, 0x3c00
    v_cvt_pk_f16_f32 v96, v66, v67
    v_cvt_pk_f16_f32 v98, v68, v69
    v_pk_mul_f16 v102, v98, v98 op_sel:[0,0] op_sel_hi:[0,1]
    v_pk_fma_f16 v102, v98, v98, v102 op_sel:[1,1,0] op_sel_hi:[1,0,1] neg_lo:[0,1,0]
    v_pk_mul_f16 v99, v95, v98 op_sel:[0,0] op_sel_hi:[0,1]
    v_pk_fma_f16 v99, v95, v98, v99 op_sel:[1,1,0] op_sel_hi:[1,0,1] neg_lo:[0,1,0]
    v_pk_mul_f16 v110, v102, v102 op_sel:[0,0] op_sel_hi:[0,1]
    v_pk_fma_f16 v110, v102, v102, v110 op_sel:[1,1,0] op_sel_hi:[1,0,1] neg_lo:[0,1,0]
    v_pk_mul_f16 v103, v95, v102 op_sel:[0,0] op_sel_hi:[0,1]
    v_pk_fma_f16 v103, v95, v102, v103 op_sel:[1,1,0] op_sel_hi:[1,0,1] neg_lo:[0,1,0]
    ds_write_addtid_b32 v123 offset:0
    ds_write_addtid_b32 v95 offset:288
    ds_write_addtid_b32 v96 offset:4608
    ds_write_addtid_b32 v98 offset:576
    ds_write_addtid_b32 v102 offset:1152
    ds_write_addtid_b32 v99 offset:864
    ds_write_addtid_b32 v110 offset:2304
    ds_write_addtid_b32 v103 offset:1440
    v_pk_mul_f16 v106, v98, v102 op_sel:[0,0] op_sel_hi:[0,1]
    v_pk_fma_f16 v106, v98, v102, v106 op_sel:[1,1,0] op_sel_hi:[1,0,1] neg_lo:[0,1,0]
    v_pk_mul_f16 v107, v99, v102 op_sel:[0,0] op_sel_hi:[0,1]
    v_pk_fma_f16 v107, v99, v102, v107 op_sel:[1,1,0] op_sel_hi:[1,0,1] neg_lo:[0,1,0]
    v_pk_mul_f16 v124, v95, v110 op_sel:[0,0] op_sel_hi:[0,1]
    v_pk_fma_f16 v124, v95, v110, v124 op_sel:[1,1,0] op_sel_hi:[1,0,1] neg_lo:[0,1,0]
    v_pk_mul_f16 v125, v98, v110 op_sel:[0,0] op_sel_hi:[0,1]
    v_pk_fma_f16 v125, v98, v110, v125 op_sel:[1,1,0] op_sel_hi:[1,0,1] neg_lo:[0,1,0]
    v_pk_mul_f16 v126, v99, v110 op_sel:[0,0] op_sel_hi:[0,1]
    v_pk_fma_f16 v126, v99, v110, v126 op_sel:[1,1,0] op_sel_hi:[1,0,1] neg_lo:[0,1,0]
    v_pk_mul_f16 v127, v102, v110 op_sel:[0,0] op_sel_hi:[0,1]
    v_pk_fma_f16 v127, v102, v110, v127 op_sel:[1,1,0] op_sel_hi:[1,0,1] neg_lo:[0,1,0]
    v_pk_mul_f16 v120, v103, v110 op_sel:[0,0] op_sel_hi:[0,1]
    v_pk_fma_f16 v120, v103, v110, v120 op_sel:[1,1,0] op_sel_hi:[1,0,1] neg_lo:[0,1,0]
    v_pk_mul_f16 v121, v106, v110 op_sel:[0,0] op_sel_hi:[0,1]
    v_pk_fma_f16 v121, v106, v110, v121 op_sel:[1,1,0] op_sel_hi:[1,0,1] neg_lo:[0,1,0]
    ds_write_addtid_b32 v106 offset:1728
    ds_write_addtid_b32 v107 offset:2016
    ds_write_addtid_b32 v124 offset:2592
    ds_write_addtid_b32 v125 offset:2880
    ds_write_addtid_b32 v126 offset:3168
    ds_write_addtid_b32 v127 offset:3456
    ds_write_addtid_b32 v120 offset:3744
    ds_write_addtid_b32 v121 offset:4032
    v_pk_mul_f16 v122, v107, v110 op_sel:[0,0] op_sel_hi:[0,1]
    v_pk_fma_f16 v122, v107, v110, v122 op_sel:[1,1,0] op_sel_hi:[1,0,1] neg_lo:[0,1,0]
    ds_write_addtid_b32 v122 offset:4320
L_tw:
    ds_read_b32 v13, v1 offset:100
    ds_read_b128 v[88:91], v15
    ds_read_b128 v[92:95], v14 offset:1024
    ds_read_b64 v[96:97], v15 offset:3072
    ds_read_b128 v[52:55], v7 offset:0
    ds_read_b128 v[104:107], v9 offset:0
    ds_read_b128 v[56:59], v7 offset:64
    ds_read_b128 v[108:111], v9 offset:64
    ds_read_b128 v[60:63], v7 offset:128
    ds_read_b128 v[112:115], v9 offset:128
    ds_read_b128 v[64:67], v7 offset:192
    ds_read_b128 v[116:119], v9 offset:192
    s_setprio 1
    s_waitcnt lgkmcnt(6)
    v_cmp_gt_u32 vcc, 4, v13
    s_cbranch_vccnz L_tws
L_twd:
    v_add_u32 v4, s56, v88
    v_add_u32 v5, s57, v89
    v_pk_mul_f16 v123, v52, v104 op_sel:[0,0] op_sel_hi:[0,1]
    v_pk_fma_f16 v104, v52, v104, v123 op_sel:[1,1,0] op_sel_hi:[1,0,1] neg_lo:[0,1,0]
    v_mfma_f32_16x16x32_f16 v[68:71], v[20:23], v[52:55], 0
    v_pk_mul_f16 v124, v53, v105 op_sel:[0,0] op_sel_hi:[0,1]
    v_pk_fma_f16 v105, v53, v105, v124 op_sel:[1,1,0] op_sel_hi:[1,0,1] neg_lo:[0,1,0]
    v_pk_mul_f16 v125, v54, v106 op_sel:[0,0] op_sel_hi:[0,1]
    v_pk_fma_f16 v106, v54, v106, v125 op_sel:[1,1,0] op_sel_hi:[1,0,1] neg_lo:[0,1,0]
    v_mfma_f32_16x16x32_f16 v[76:79], v[36:39], v[52:55], 0
    v_pk_mul_f16 v126, v55, v107 op_sel:[0,0] op_sel_hi:[0,1]
    v_pk_fma_f16 v107, v55, v107, v126 op_sel:[1,1,0] op_sel_hi:[1,0,1] neg_lo:[0,1,0]
    s_waitcnt lgkmcnt(4)
    v_add_u32 v6, s57, v90
    v_add_u32 v10, s60, v91
    v_pk_mul_f16 v127, v56, v108 op_sel:[0,0] op_sel_hi:[0,1]
    v_pk_fma_f16 v108, v56, v108, v127 op_sel:[1,1,0] op_sel_hi:[1,0,1] neg_lo:[0,1,0]
    v_mfma_f32_16x16x32_f16 v[68:71], v[24:27], v[56:59], v[68:71]
    v_pk_mul_f16 v120, v57, v109 op_sel:[0,0] op_sel_hi:[0,1]
    v_pk_fma_f16 v109, v57, v109, v120 op_sel:[1,1,0] op_sel_hi:[1,0,1] neg_lo:[0,1,0]
    v_mfma_f32_16x16x32_f16 v[72:75], v[20:23], v[104:107], 0
    v_pk_mul_f16 v121, v58, v110 op_sel:[0,0] op_sel_hi:[0,1]
    v_pk_fma_f16 v110, v58, v110, v121 op_sel:[1,1,0] op_sel_hi:[1,0,1] neg_lo:[0,1,0]
    v_mfma_f32_16x16x32_f16 v[76:79], v[40:43], v[56:59], v[76:79]
    v_pk_mul_f16 v122, v59, v111 op_sel:[0,0] op_sel_hi:[0,1]
    v_pk_fma_f16 v111, v59, v111, v122 op_sel:[1,1,0] op_sel_hi:[1,0,1] neg_lo:[0,1,0]
    v_mfma_f32_16x16x32_f16 v[80:83], v[36:39], v[104:107], 0
    s_waitcnt lgkmcnt(2)
    v_add_u32 v0, s61, v92
    v_pk_mul_f16 v123, v60, v112 op_sel:[0,0] op_sel_hi:[0,1]
    v_pk_fma_f16 v112, v60, v112, v123 op_sel:[1,1,0] op_sel_hi:[1,0,1] neg_lo:[0,1,0]
    v_mfma_f32_16x16x32_f16 v[68:71], v[28:31], v[60:63], v[68:71]
    v_pk_mul_f16 v124, v61, v113 op_sel:[0,0] op_sel_hi:[0,1]
    v_pk_fma_f16 v113, v61, v113, v124 op_sel:[1,1,0] op_sel_hi:[1,0,1] neg_lo:[0,1,0]
    v_mfma_f32_16x16x32_f16 v[72:75], v[24:27], v[108:111], v[72:75]
    v_pk_mul_f16 v125, v62, v114 op_sel:[0,0] op_sel_hi:[0,1]
    v_pk_fma_f16 v114, v62, v114, v125 op_sel:[1,1,0] op_sel_hi:[1,0,1] neg_lo:[0,1,0]
    v_mfma_f32_16x16x32_f16 v[76:79], v[44:47], v[60:63], v[76:79]
    v_pk_mul_f16 v126, v63, v115 op_sel:[0,0] op_sel_hi:[0,1]
    v_pk_fma_f16 v115, v63, v115, v126 op_sel:[1,1,0] op_sel_hi:[1,0,1] neg_lo:[0,1,0]
    v_mfma_f32_16x16x32_f16 v[80:83], v[40:43], v[108:111], v[80:83]
    s_setprio 0
    s_waitcnt lgkmcnt(0)
    v_add_u32 v11, s57, v93
    v_pk_mul_f16 v127, v64, v116 op_sel:[0,0] op_sel_hi:[0,1]
    v_pk_fma_f16 v116, v64, v116, v127 op_sel:[1,1,0] op_sel_hi:[1,0,1] neg_lo:[0,1,0]
    v_mfma_f32_16x16x32_f16 v[68:71], v[32:35], v[64:67], v[68:71]
    v_pk_mul_f16 v120, v65, v117 op_sel:[0,0] op_sel_hi:[0,1]
    v_pk_fma_f16 v117, v65, v117, v120 op_sel:[1,1,0] op_sel_hi:[1,0,1] neg_lo:[0,1,0]
    v_mfma_f32_16x16x32_f16 v[72:75], v[28:31], v[112:115], v[72:75]
    v_pk_mul_f16 v121, v66, v118 op_sel:[0,0] op_sel_hi:[0,1]
    v_pk_fma_f16 v118, v66, v118, v121 op_sel:[1,1,0] op_sel_hi:[1,0,1] neg_lo:[0,1,0]
    v_mfma_f32_16x16x32_f16 v[76:79], v[48:51], v[64:67], v[76:79]
    v_pk_mul_f16 v122, v67, v119 op_sel:[0,0] op_sel_hi:[0,1]
    v_pk_fma_f16 v119, v67, v119, v122 op_sel:[1,1,0] op_sel_hi:[1,0,1] neg_lo:[0,1,0]
    v_mfma_f32_16x16x32_f16 v[80:83], v[44:47], v[112:115], v[80:83]
    s_nop 1
    v_mfma_f32_16x16x32_f16 v[72:75], v[32:35], v[116:119], v[72:75]
    v_mfma_f32_16x16x32_f16 v[80:83], v[48:51], v[116:119], v[80:83]
    s_setprio 3
    s_nop 0
    v_cvt_pk_f16_f32 v20, v68, v69
    v_cvt_pk_f16_f32 v21, v70, v71
    ds_write_b64 v10, v[20:21]
    s_cmp_lg_u32 s62, 0
    s_cbranch_scc1 L_xL
    v_cvt_pk_f16_f32 v26, v78, v78
    ds_write_addtid_b32 v26 offset:1536
    s_nop 0
    v_cvt_pk_f16_f32 v22, v72, v73
    v_cvt_pk_f16_f32 v23, v74, v75
    v_cvt_pk_f16_f32 v24, v80, v76
    v_cvt_pk_f16_f32 v25, v81, v77
    ds_write_b64 v10, v[22:23] offset:32
    ds_write_addtid_b32 v24 offset:1024
    ds_write_addtid_b32 v25 offset:1280
    ds_write_b32 v1, v2
L_w_pxd:
    ds_read_b32 v20, v1 offset:4
    s_waitcnt lgkmcnt(0)
    v_cmp_eq_u32 vcc, 0, v20
    s_cbranch_vccnz L_ws_pxd
L_wd_pxd:
    ds_read_b128 v[100:103], v0
    ds_read_b128 v[104:107], v0 offset:4896
    s_waitcnt lgkmcnt(0)
    v_pk_add_f16 v102, v102, v106
    v_pk_add_f16 v103, v103, v107
    v_pk_add_f16 v100, v100, v104
    v_pk_add_f16 v101, v101, v105
    v_fma_mix_f32 v93, v102, v86, 0 op_sel:[1,0,0] op_sel_hi:[1,0,0]
    v_fma_mix_f32 v94, v103, v86, 0 op_sel:[0,0,0] op_sel_hi:[1,0,0]
    v_fma_mix_f32 v95, v103, v86, 0 op_sel:[1,0,0] op_sel_hi:[1,0,0]
    v_fma_mix_f32 v92, v102, v86, 0 op_sel:[0,0,0] op_sel_hi:[1,0,0]
    v_fma_mix_f32 v88, v100, v86, v85 op_sel:[0,0,0] op_sel_hi:[1,0,0]
    v_fma_mix_f32 v89, v100, v86, 0 op_sel:[1,0,0] op_sel_hi:[1,0,0]
    v_fma_mix_f32 v90, v101, v86, 0 op_sel:[0,0,0] op_sel_hi:[1,0,0]
    v_fma_mix_f32 v91, v101, v86, 0 op_sel:[1,0,0] op_sel_hi:[1,0,0]
    v_mov_b32_dpp v96, v93 wave_shr:1 row_mask:0xf bank_mask:0xf bound_ctrl:0
    v_mov_b32_dpp v97, v94 wave_shr:1 row_mask:0xf bank_mask:0xf bound_ctrl:0
    v_mov_b32_dpp v98, v95 wave_shr:1 row_mask:0xf bank_mask:0xf bound_ctrl:0
    v_cvt_pk_bf16_f32 v108, v95, v94
    v_cvt_pk_bf16_f32 v109, v93, v92
    v_cvt_pk_bf16_f32 v110, v91, v90
    v_cvt_pk_bf16_f32 v111, v89, v88
    ds_write_b128 v11, v[108:111]
    v_cvt_pk_bf16_f32 v112, v94, v93
    v_cvt_pk_bf16_f32 v113, v92, v91
    v_cvt_pk_bf16_f32 v114, v90, v89
    v_cvt_pk_bf16_f32 v115, v88, v98
    ds_write_b128 v11, v[112:115] offset:2112
    v_mov_b32 v116, v109
    v_mov_b32 v117, v110
    v_mov_b32 v118, v111
    v_cvt_pk_bf16_f32 v119, v98, v97
    ds_write_b128 v11, v[116:119] offset:4224
    v_mov_b32 v120, v113
    v_mov_b32 v121, v114
    v_mov_b32 v122, v115
    v_cvt_pk_bf16_f32 v123, v97, v96
    ds_write_b128 v11, v[120:123] offset:6336
    ds_write_b32 v1, v2 offset:8
    ds_read_b64 v[20:21], v5 offset:1048
    ds_read_b64 v[22:23], v5 offset:1056
    ds_read_b64 v[24:25], v5 offset:984
    ds_read_b64 v[26:27], v5 offset:992
    ds_read_b64 v[28:29], v5 offset:920
    ds_read_b64 v[30:31], v5 offset:928
    ds_read_b64 v[32:33], v5 offset:856
    ds_read_b64 v[34:35], v5 offset:864
    ds_read_b64 v[36:37], v5 offset:792
    ds_read_b64 v[38:39], v5 offset:800
    ds_read_b64 v[40:41], v5 offset:728
    ds_read_b64 v[42:43], v5 offset:736
    ds_read_b64 v[44:45], v5 offset:664
    ds_read_b64 v[46:47], v5 offset:672
    ds_read_b64 v[48:49], v5 offset:600
    ds_read_b64 v[50:51], v5 offset:608
    ds_read_b64 v[52:53], v5 offset:536
    ds_read_b64 v[54:55], v5 offset:544
    ds_read_b64 v[56:57], v5 offset:472
    ds_read_b64 v[58:59], v5 offset:480
    ds_read_b64 v[60:61], v5 offset:408
    ds_read_b64 v[62:63], v5 offset:416
    ds_read_b64 v[64:65], v5 offset:344
    ds_read_b64 v[66:67], v5 offset:352
    ds_read_b64 v[68:69], v5 offset:280
    ds_read_b64 v[70:71], v5 offset:288
    ds_read_b64 v[72:73], v5 offset:216
    ds_read_b64 v[74:75], v5 offset:224
    ds_read_b64 v[76:77], v5 offset:152
    ds_read_b64 v[78:79], v5 offset:160
    s_setprio 3
L_w_d:
    ds_read_b32 v18, v1 offset:16
    s_waitcnt lgkmcnt(0)
    v_lshrrev_b32 v18, 2, v18
    v_cmp_eq_u32 vcc, 0, v18
    s_cbranch_vccnz L_ws_d
L_wd_d:
    ds_read_b128 v[96:99], v4 offset:480
    ds_read_b128 v[100:103], v4 offset:416
    ds_read_b128 v[104:107], v4 offset:352
    ds_read_b128 v[108:111], v4 offset:288
    ds_read_b128 v[112:115], v4 offset:224
    ds_read_b128 v[116:119], v4 offset:160
    ds_read_b128 v[120:123], v4 offset:96
    s_waitcnt lgkmcnt(6)
    v_mfma_f32_16x16x32_bf16 v[84:87], v[20:23], v[96:99], 0
    ds_read_b128 v[124:127], v4 offset:32
    s_waitcnt lgkmcnt(6)
    v_mfma_f32_16x16x32_bf16 v[84:87], v[24:27], v[100:103], v[84:87]
    s_waitcnt lgkmcnt(5)
    v_mfma_f32_16x16x32_bf16 v[84:87], v[28:31], v[104:107], v[84:87]
    s_waitcnt lgkmcnt(4)
    v_mfma_f32_16x16x32_bf16 v[84:87], v[32:35], v[108:111], v[84:87]
    s_waitcnt lgkmcnt(3)
    v_mfma_f32_16x16x32_bf16 v[84:87], v[36:39], v[112:115], v[84:87]
    s_waitcnt lgkmcnt(2)
    v_mfma_f32_16x16x32_bf16 v[84:87], v[40:43], v[116:119], v[84:87]
    s_waitcnt lgkmcnt(1)
    v_mfma_f32_16x16x32_bf16 v[84:87], v[44:47], v[120:123], v[84:87]
    s_waitcnt lgkmcnt(0)
    v_mfma_f32_16x16x32_bf16 v[84:87], v[48:51], v[124:127], v[84:87]
    v_mfma_f32_16x16x32_bf16 v[88:91], v[52:55], v[96:99], 0
    v_mfma_f32_16x16x32_bf16 v[88:91], v[56:59], v[100:103], v[88:91]
    ds_read_b32 v18, v1 offset:12
    ds_read_b128 v[96:99], v4 offset:992
    v_mfma_f32_16x16x32_bf16 v[88:91], v[60:63], v[104:107], v[88:91]
    ds_read_b128 v[100:103], v4 offset:928
    v_mfma_f32_16x16x32_bf16 v[88:91], v[64:67], v[108:111], v[88:91]
    ds_read_b128 v[104:107], v4 offset:864
    v_mfma_f32_16x16x32_bf16 v[88:91], v[68:71], v[112:115], v[88:91]
    v_cvt_pk_bf16_f32 v16, v84, v85
    v_cvt_pk_bf16_f32 v17, v86, v87
    ds_read_b128 v[108:111], v4 offset:800
    v_mfma_f32_16x16x32_bf16 v[88:91], v[72:75], v[116:119], v[88:91]
    ds_write_addtid_b32 v16 offset:6144
    v_mov_b32 v8, 1
    ds_write_addtid_b32 v17 offset:6400
    ds_write_addtid_b32 v8 offset:10240
    s_waitcnt lgkmcnt(7)
    v_cmp_eq_u32 vcc, 0, v18
    s_cbranch_vccnz L_sp_kl
L_ok_kl:
    ds_read_b64 v[80:81], v5 offset:88
    ds_read_b64 v[82:83], v5 offset:96
    ds_read_b128 v[112:115], v4 offset:736
    v_mfma_f32_16x16x32_bf16 v[88:91], v[76:79], v[120:123], v[88:91]
    ds_read_b128 v[116:119], v4 offset:672
    s_waitcnt lgkmcnt(2)
    v_mfma_f32_16x16x32_bf16 v[88:91], v[80:83], v[124:127], v[88:91]
    ds_read_b128 v[120:123], v4 offset:608
    v_mfma_f32_16x16x32_bf16 v[88:91], v[20:23], v[96:99], v[88:91]
    ds_read_b128 v[124:127], v4 offset:544
    v_mfma_f32_16x16x32_bf16 v[88:91], v[24:27], v[100:103], v[88:91]
    v_mfma_f32_16x16x32_bf16 v[88:91], v[28:31], v[104:107], v[88:91]
    v_mfma_f32_16x16x32_bf16 v[88:91], v[32:35], v[108:111], v[88:91]
    s_waitcnt lgkmcnt(3)
    v_mfma_f32_16x16x32_bf16 v[88:91], v[36:39], v[112:115], v[88:91]
    s_waitcnt lgkmcnt(2)
    v_mfma_f32_16x16x32_bf16 v[88:91], v[40:43], v[116:119], v[88:91]
    s_waitcnt lgkmcnt(1)
    v_mfma_f32_16x16x32_bf16 v[88:91], v[44:47], v[120:123], v[88:91]
    s_waitcnt lgkmcnt(0)
    v_mfma_f32_16x16x32_bf16 v[88:91], v[48:51], v[124:127], v[88:91]
    s_cmp_ge_u32 s45, 4
    s_cbranch_scc1 L_cp2
    s_setprio 2
L_cp2:
    v_mfma_f32_16x16x32_bf16 v[92:95], v[52:55], v[96:99], 0
    v_mfma_f32_16x16x32_bf16 v[92:95], v[56:59], v[100:103], v[92:95]
    ds_read_b128 v[96:99], v4 offset:1504
    v_mfma_f32_16x16x32_bf16 v[92:95], v[60:63], v[104:107], v[92:95]
    ds_read_b128 v[100:103], v4 offset:1440
    v_mfma_f32_16x16x32_bf16 v[92:95], v[64:67], v[108:111], v[92:95]
    v_cvt_pk_bf16_f32 v16, v88, v89
    v_cvt_pk_bf16_f32 v17, v90, v91
    ds_read_b128 v[104:107], v4 offset:1376
    v_mfma_f32_16x16x32_bf16 v[92:95], v[68:71], v[112:115], v[92:95]
    ds_write_addtid_b32 v16 offset:6656
    v_mov_b32 v8, 2
    ds_read_b128 v[108:111], v4 offset:1312
    v_mfma_f32_16x16x32_bf16 v[92:95], v[72:75], v[116:119], v[92:95]
    ds_write_addtid_b32 v17 offset:6912
    ds_read_b128 v[112:115], v4 offset:1248
    v_mfma_f32_16x16x32_bf16 v[92:95], v[76:79], v[120:123], v[92:95]
    ds_write_addtid_b32 v8 offset:10240
    ds_read_b128 v[116:119], v4 offset:1184
    v_mfma_f32_16x16x32_bf16 v[92:95], v[80:83], v[124:127], v[92:95]
    ds_read_b128 v[120:123], v4 offset:1120
    s_waitcnt lgkmcnt(9)
    v_mfma_f32_16x16x32_bf16 v[92:95], v[20:23], v[96:99], v[92:95]
    ds_read_b128 v[124:127], v4 offset:1056
    s_waitcnt lgkmcnt(9)
    v_mfma_f32_16x16x32_bf16 v[92:95], v[24:27], v[100:103], v[92:95]
    s_waitcnt lgkmcnt(8)
    v_mfma_f32_16x16x32_bf16 v[92:95], v[28:31], v[104:107], v[92:95]
    s_waitcnt lgkmcnt(6)
    v_mfma_f32_16x16x32_bf16 v[92:95], v[32:35], v[108:111], v[92:95]
    s_waitcnt lgkmcnt(4)
    v_mfma_f32_16x16x32_bf16 v[92:95], v[36:39], v[112:115], v[92:95]
    ds_read_addtid_b32 v18 offset:10496
    ds_read_b128 v[12:15], v0 offset:0
    s_waitcnt lgkmcnt(4)
    v_mfma_f32_16x16x32_bf16 v[92:95], v[40:43], v[116:119], v[92:95]
    s_waitcnt lgkmcnt(3)
    v_mfma_f32_16x16x32_bf16 v[92:95], v[44:47], v[120:123], v[92:95]
    s_waitcnt lgkmcnt(2)
    v_mfma_f32_16x16x32_bf16 v[92:95], v[48:51], v[124:127], v[92:95]
    s_cmp_ge_u32 s45, 4
    s_cbranch_scc0 L_cp3
    s_setprio 2
L_cp3:
    v_mfma_f32_16x16x32_bf16 v[84:87], v[52:55], v[96:99], 0
    s_waitcnt lgkmcnt(0)
    v_cmp_gt_u32 vcc, 2, v18
    s_cbranch_vccnz L_sp_p2
L_ok_p2:
    v_mfma_f32_16x16x32_bf16 v[84:87], v[56:59], v[100:103], v[84:87]
    ds_read_b128 v[96:99], v4 offset:2016
    v_mfma_f32_16x16x32_bf16 v[84:87], v[60:63], v[104:107], v[84:87]
    v_add_f32 v12, v12, v92
    v_add_f32 v13, v13, v93
    ds_read_b128 v[100:103], v4 offset:1952
    v_mfma_f32_16x16x32_bf16 v[84:87], v[64:67], v[108:111], v[84:87]
    v_add_f32 v14, v14, v94
    v_add_f32 v15, v15, v95
    ds_read_b128 v[104:107], v4 offset:1888
    v_mfma_f32_16x16x32_bf16 v[84:87], v[68:71], v[112:115], v[84:87]
    v_cvt_pk_bf16_f32 v16, v12, v13
    v_cvt_pk_bf16_f32 v17, v14, v15
    ds_read_b128 v[108:111], v4 offset:1824
    v_mfma_f32_16x16x32_bf16 v[84:87], v[72:75], v[116:119], v[84:87]
    ds_write_addtid_b32 v16 offset:7168
    v_mov_b32 v8, 3
    ds_read_b128 v[112:115], v4 offset:1760
    v_mfma_f32_16x16x32_bf16 v[84:87], v[76:79], v[120:123], v[84:87]
    ds_write_addtid_b32 v17 offset:7424
    ds_read_b128 v[116:119], v4 offset:1696
    v_mfma_f32_16x16x32_bf16 v[84:87], v[80:83], v[124:127], v[84:87]
    ds_write_addtid_b32 v8 offset:10240
    ds_read_b128 v[120:123], v4 offset:1632
    s_waitcnt lgkmcnt(9)
    v_mfma_f32_16x16x32_bf16 v[84:87], v[20:23], v[96:99], v[84:87]
    ds_read_b128 v[124:127], v4 offset:1568
    s_waitcnt lgkmcnt(9)
    v_mfma_f32_16x16x32_bf16 v[84:87], v[24:27], v[100:103], v[84:87]
    s_waitcnt lgkmcnt(8)
    v_mfma_f32_16x16x32_bf16 v[84:87], v[28:31], v[104:107], v[84:87]
    s_waitcnt lgkmcnt(7)
    v_mfma_f32_16x16x32_bf16 v[84:87], v[32:35], v[108:111], v[84:87]
    s_waitcnt lgkmcnt(5)
    v_mfma_f32_16x16x32_bf16 v[84:87], v[36:39], v[112:115], v[84:87]
    ds_read_addtid_b32 v18 offset:10496
    ds_read_b128 v[12:15], v0 offset:1024
    s_waitcnt lgkmcnt(5)
    v_mfma_f32_16x16x32_bf16 v[84:87], v[40:43], v[116:119], v[84:87]
    s_waitcnt lgkmcnt(3)
    v_mfma_f32_16x16x32_bf16 v[84:87], v[44:47], v[120:123], v[84:87]
    s_waitcnt lgkmcnt(2)
    v_mfma_f32_16x16x32_bf16 v[84:87], v[48:51], v[124:127], v[84:87]
    ds_read_b32 v10, v1 offset:20
    s_cmp_ge_u32 s45, 4
    s_cbranch_scc1 L_cp4
    s_setprio 1
L_cp4:
    v_mfma_f32_16x16x32_bf16 v[88:91], v[52:55], v[96:99], 0
    s_waitcnt lgkmcnt(1)
    v_cmp_gt_u32 vcc, 3, v18
    s_cbranch_vccnz L_sp_p3
L_ok_p3:
    v_mfma_f32_16x16x32_bf16 v[88:91], v[56:59], v[100:103], v[88:91]
    v_add_f32 v12, v12, v84
    v_add_f32 v13, v13, v85
    s_waitcnt lgkmcnt(0)
    v_cmp_gt_u32 vcc, 4, v10
    s_cbranch_vccnz L_sp_du4
L_ok_du4:
    ds_read_b128 v[96:99], v4 offset:2528
    v_mfma_f32_16x16x32_bf16 v[88:91], v[60:63], v[104:107], v[88:91]
    v_add_f32 v14, v14, v86
    v_add_f32 v15, v15, v87
    ds_read_b128 v[100:103], v4 offset:2464
    v_mfma_f32_16x16x32_bf16 v[88:91], v[64:67], v[108:111], v[88:91]
    v_cvt_pk_bf16_f32 v16, v12, v13
    v_cvt_pk_bf16_f32 v17, v14, v15
    ds_read_b128 v[104:107], v4 offset:2400
    v_mfma_f32_16x16x32_bf16 v[88:91], v[68:71], v[112:115], v[88:91]
    ds_write_addtid_b32 v16 offset:7680
    v_mov_b32 v8, 4
    ds_read_b128 v[108:111], v4 offset:2336
    v_mfma_f32_16x16x32_bf16 v[88:91], v[72:75], v[116:119], v[88:91]
    ds_write_addtid_b32 v17 offset:7936
    ds_read_b128 v[112:115], v4 offset:2272
    v_mfma_f32_16x16x32_bf16 v[88:91], v[76:79], v[120:123], v[88:91]
    ds_write_addtid_b32 v8 offset:10240
    ds_read_b128 v[116:119], v4 offset:2208
    v_mfma_f32_16x16x32_bf16 v[88:91], v[80:83], v[124:127], v[88:91]
    ds_read_b128 v[120:123], v4 offset:2144
    s_waitcnt lgkmcnt(9)
    v_mfma_f32_16x16x32_bf16 v[88:91], v[20:23], v[96:99], v[88:91]
    ds_read_b128 v[124:127], v4 offset:2080
    s_waitcnt lgkmcnt(9)
    v_mfma_f32_16x16x32_bf16 v[88:91], v[24:27], v[100:103], v[88:91]
    s_waitcnt lgkmcnt(8)
    v_mfma_f32_16x16x32_bf16 v[88:91], v[28:31], v[104:107], v[88:91]
    s_waitcnt lgkmcnt(6)
    v_mfma_f32_16x16x32_bf16 v[88:91], v[32:35], v[108:111], v[88:91]
    s_waitcnt lgkmcnt(4)
    v_mfma_f32_16x16x32_bf16 v[88:91], v[36:39], v[112:115], v[88:91]
    ds_read_addtid_b32 v18 offset:10496
    ds_read_b128 v[12:15], v0 offset:2048
    s_waitcnt lgkmcnt(4)
    v_mfma_f32_16x16x32_bf16 v[88:91], v[40:43], v[116:119], v[88:91]
    s_waitcnt lgkmcnt(3)
    v_mfma_f32_16x16x32_bf16 v[88:91], v[44:47], v[120:123], v[88:91]
    s_waitcnt lgkmcnt(2)
    v_mfma_f32_16x16x32_bf16 v[88:91], v[48:51], v[124:127], v[88:91]
    s_cmp_ge_u32 s45, 4
    s_cbranch_scc0 L_cp5
    s_setprio 1
L_cp5:
    v_mfma_f32_16x16x32_bf16 v[92:95], v[52:55], v[96:99], 0
    s_waitcnt lgkmcnt(0)
    v_cmp_gt_u32 vcc, 4, v18
    s_cbranch_vccnz L_sp_p4
L_ok_p4:
    v_mfma_f32_16x16x32_bf16 v[92:95], v[56:59], v[100:103], v[92:95]
    ds_read_b128 v[96:99], v4 offset:3040
    v_mfma_f32_16x16x32_bf16 v[92:95], v[60:63], v[104:107], v[92:95]
    v_add_f32 v12, v12, v88
    v_add_f32 v13, v13, v89
    ds_read_b128 v[100:103], v4 offset:2976
    v_mfma_f32_16x16x32_bf16 v[92:95], v[64:67], v[108:111], v[92:95]
    v_add_f32 v14, v14, v90
    v_add_f32 v15, v15, v91
    ds_read_b128 v[104:107], v4 offset:2912
    v_mfma_f32_16x16x32_bf16 v[92:95], v[68:71], v[112:115], v[92:95]
    v_cvt_pk_bf16_f32 v16, v12, v13
    v_cvt_pk_bf16_f32 v17, v14, v15
    ds_read_b128 v[108:111], v4 offset:2848
    v_mfma_f32_16x16x32_bf16 v[92:95], v[72:75], v[116:119], v[92:95]
    ds_write_addtid_b32 v16 offset:8192
    v_mov_b32 v8, 5
    ds_read_b128 v[112:115], v4 offset:2784
    v_mfma_f32_16x16x32_bf16 v[92:95], v[76:79], v[120:123], v[92:95]
    ds_write_addtid_b32 v17 offset:8448
    ds_read_b128 v[116:119], v4 offset:2720
    v_mfma_f32_16x16x32_bf16 v[92:95], v[80:83], v[124:127], v[92:95]
    ds_write_addtid_b32 v8 offset:10240
    ds_read_b128 v[120:123], v4 offset:2656
    s_waitcnt lgkmcnt(9)
    v_mfma_f32_16x16x32_bf16 v[92:95], v[20:23], v[96:99], v[92:95]
    ds_read_b128 v[124:127], v4 offset:2592
    s_waitcnt lgkmcnt(9)
    v_mfma_f32_16x16x32_bf16 v[92:95], v[24:27], v[100:103], v[92:95]
    s_waitcnt lgkmcnt(8)
    v_mfma_f32_16x16x32_bf16 v[92:95], v[28:31], v[104:107], v[92:95]
    s_waitcnt lgkmcnt(7)
    v_mfma_f32_16x16x32_bf16 v[92:95], v[32:35], v[108:111], v[92:95]
    s_waitcnt lgkmcnt(5)
    v_mfma_f32_16x16x32_bf16 v[92:95], v[36:39], v[112:115], v[92:95]
    ds_read_addtid_b32 v18 offset:10496
    ds_read_b128 v[12:15], v0 offset:3072
    s_waitcnt lgkmcnt(5)
    v_mfma_f32_16x16x32_bf16 v[92:95], v[40:43], v[116:119], v[92:95]
    s_waitcnt lgkmcnt(3)
    v_mfma_f32_16x16x32_bf16 v[92:95], v[44:47], v[120:123], v[92:95]
    s_waitcnt lgkmcnt(2)
    v_mfma_f32_16x16x32_bf16 v[92:95], v[48:51], v[124:127], v[92:95]
    s_cmp_ge_u32 s45, 4
    s_cbranch_scc1 L_cp6
    s_setprio 0
L_cp6:
    v_mfma_f32_16x16x32_bf16 v[84:87], v[52:55], v[96:99], 0
    s_waitcnt lgkmcnt(0)
    v_cmp_gt_u32 vcc, 5, v18
    s_cbranch_vccnz L_sp_p5
L_ok_p5:
    v_mfma_f32_16x16x32_bf16 v[84:87], v[56:59], v[100:103], v[84:87]
    ds_read_b128 v[96:99], v4 offset:3552
    v_mfma_f32_16x16x32_bf16 v[84:87], v[60:63], v[104:107], v[84:87]
    v_add_f32 v12, v12, v92
    v_add_f32 v13, v13, v93
    ds_read_b128 v[100:103], v4 offset:3488
    v_mfma_f32_16x16x32_bf16 v[84:87], v[64:67], v[108:111], v[84:87]
    v_add_f32 v14, v14, v94
    v_add_f32 v15, v15, v95
    ds_read_b128 v[104:107], v4 offset:3424
    v_mfma_f32_16x16x32_bf16 v[84:87], v[68:71], v[112:115], v[84:87]
    v_cvt_pk_bf16_f32 v16, v12, v13
    v_cvt_pk_bf16_f32 v17, v14, v15
    ds_read_b128 v[108:111], v4 offset:3360
    v_mfma_f32_16x16x32_bf16 v[84:87], v[72:75], v[116:119], v[84:87]
    ds_write_addtid_b32 v16 offset:8704
    v_mov_b32 v8, 6
    ds_read_b128 v[112:115], v4 offset:3296
    v_mfma_f32_16x16x32_bf16 v[84:87], v[76:79], v[120:123], v[84:87]
    ds_write_addtid_b32 v17 offset:8960
    ds_read_b128 v[116:119], v4 offset:3232
    v_mfma_f32_16x16x32_bf16 v[84:87], v[80:83], v[124:127], v[84:87]
    ds_write_addtid_b32 v8 offset:10240
    ds_read_b128 v[120:123], v4 offset:3168
    s_waitcnt lgkmcnt(9)
    v_mfma_f32_16x16x32_bf16 v[84:87], v[20:23], v[96:99], v[84:87]
    ds_read_b128 v[124:127], v4 offset:3104
    s_waitcnt lgkmcnt(9)
    v_mfma_f32_16x16x32_bf16 v[84:87], v[24:27], v[100:103], v[84:87]
    s_waitcnt lgkmcnt(8)
    v_mfma_f32_16x16x32_bf16 v[84:87], v[28:31], v[104:107], v[84:87]
    s_waitcnt lgkmcnt(7)
    v_mfma_f32_16x16x32_bf16 v[84:87], v[32:35], v[108:111], v[84:87]
    s_waitcnt lgkmcnt(5)
    v_mfma_f32_16x16x32_bf16 v[84:87], v[36:39], v[112:115], v[84:87]
    ds_read_addtid_b32 v18 offset:10496
    ds_read_b128 v[12:15], v0 offset:4096
    s_waitcnt lgkmcnt(5)
    v_mfma_f32_16x16x32_bf16 v[84:87], v[40:43], v[116:119], v[84:87]
    s_waitcnt lgkmcnt(3)
    v_mfma_f32_16x16x32_bf16 v[84:87], v[44:47], v[120:123], v[84:87]
    s_waitcnt lgkmcnt(2)
    v_mfma_f32_16x16x32_bf16 v[84:87], v[48:51], v[124:127], v[84:87]
    s_cmp_ge_u32 s45, 4
    s_cbranch_scc0 L_cp7
    s_setprio 0
L_cp7:
    v_mfma_f32_16x16x32_bf16 v[88:91], v[52:55], v[96:99], 0
    s_waitcnt lgkmcnt(0)
    v_cmp_gt_u32 vcc, 6, v18
    s_cbranch_vccnz L_sp_p6
L_ok_p6:
    v_mfma_f32_16x16x32_bf16 v[88:91], v[56:59], v[100:103], v[88:91]
    ds_read_b128 v[96:99], v4 offset:4064
    v_mfma_f32_16x16x32_bf16 v[88:91], v[60:63], v[104:107], v[88:91]
    v_add_f32 v12, v12, v84
    v_add_f32 v13, v13, v85
    ds_read_b128 v[100:103], v4 offset:4000
    v_mfma_f32_16x16x32_bf16 v[88:91], v[64:67], v[108:111], v[88:91]
    v_add_f32 v14, v14, v86
    v_add_f32 v15, v15, v87
    ds_read_b128 v[104:107], v4 offset:3936
    v_mfma_f32_16x16x32_bf16 v[88:91], v[68:71], v[112:115], v[88:91]
    v_cvt_pk_bf16_f32 v16, v12, v13
    v_cvt_pk_bf16_f32 v17, v14, v15
    ds_read_b128 v[108:111], v4 offset:3872
    v_mfma_f32_16x16x32_bf16 v[88:91], v[72:75], v[116:119], v[88:91]
    ds_write_addtid_b32 v16 offset:9216
    v_mov_b32 v8, 7
    ds_read_b128 v[112:115], v4 offset:3808
    v_mfma_f32_16x16x32_bf16 v[88:91], v[76:79], v[120:123], v[88:91]
    ds_write_addtid_b32 v17 offset:9472
    ds_read_b128 v[116:119], v4 offset:3744
    v_mfma_f32_16x16x32_bf16 v[88:91], v[80:83], v[124:127], v[88:91]
    ds_write_addtid_b32 v8 offset:10240
    ds_read_b128 v[120:123], v4 offset:3680
    s_waitcnt lgkmcnt(9)
    v_mfma_f32_16x16x32_bf16 v[88:91], v[20:23], v[96:99], v[88:91]
    ds_read_b128 v[96:99], v4 offset:3616
    s_waitcnt lgkmcnt(9)
    v_mfma_f32_16x16x32_bf16 v[88:91], v[24:27], v[100:103], v[88:91]
    s_waitcnt lgkmcnt(8)
    v_mfma_f32_16x16x32_bf16 v[88:91], v[28:31], v[104:107], v[88:91]
    s_waitcnt lgkmcnt(7)
    v_mfma_f32_16x16x32_bf16 v[88:91], v[32:35], v[108:111], v[88:91]
    s_waitcnt lgkmcnt(5)
    v_mfma_f32_16x16x32_bf16 v[88:91], v[36:39], v[112:115], v[88:91]
    ds_read_addtid_b32 v18 offset:10496
    ds_read_b128 v[12:15], v0 offset:5120
    s_waitcnt lgkmcnt(5)
    v_mfma_f32_16x16x32_bf16 v[88:91], v[40:43], v[116:119], v[88:91]
    s_waitcnt lgkmcnt(3)
    v_mfma_f32_16x16x32_bf16 v[88:91], v[44:47], v[120:123], v[88:91]
    s_waitcnt lgkmcnt(2)
    v_mfma_f32_16x16x32_bf16 v[88:91], v[48:51], v[96:99], v[88:91]
    s_waitcnt lgkmcnt(0)
    v_cmp_gt_u32 vcc, 7, v18
    s_cbranch_vccnz L_sp_p7
L_ok_p7:
    s_nop 4
    v_add_f32 v12, v12, v88
    v_add_f32 v13, v13, v89
    v_add_f32 v14, v14, v90
    v_add_f32 v15, v15, v91
    v_cvt_pk_bf16_f32 v16, v12, v13
    v_cvt_pk_bf16_f32 v17, v14, v15
    ds_write_addtid_b32 v16 offset:9728
    v_mov_b32 v8, 8
    ds_write_addtid_b32 v17 offset:9984
    ds_write_addtid_b32 v8 offset:10240
    s_branch L_fin
L_xL:
    v_mov_b32 v28, s61
    v_add_u32 v12, s57, v94
    v_add_u32 v13, s57, v95
    v_cvt_pk_f16_f32 v22, v72, v73
    v_cvt_pk_f16_f32 v23, v74, v75
    ds_write_b64 v10, v[22:23] offset:32
    ds_write_b32 v1, v2 offset:4
    s_mov_b32 m0, s61
    v_add_u32 v14, s57, v96
    v_add_u32 v3, s57, v97
    v_subrev_u32 v19, 4096, v15
    s_mov_b32 s8, 1
L_w_pxl:
    ds_read_b32 v21, v1 offset:0
    s_waitcnt lgkmcnt(0)
    v_cmp_eq_u32 vcc, 0, v21
    s_cbranch_vccnz L_ws_pxl
L_wd_pxl:
    ds_read_addtid_b32 v24 offset:1024
    ds_read_addtid_b32 v25 offset:1280
    ds_read_addtid_b32 v26 offset:1536
    ds_read_b64 v[32:33], v28 offset:1016
    ds_read_b64 v[34:35], v28 offset:5912
    s_waitcnt lgkmcnt(3)
    v_fma_mix_f32 v36, v24, 1.0, v76 op_sel:[1,0,0] op_sel_hi:[1,0,0]
    v_fma_mix_f32 v37, v24, 1.0, v80 op_sel:[0,0,0] op_sel_hi:[1,0,0]
    v_fma_mix_f32 v38, v25, 1.0, v77 op_sel:[1,0,0] op_sel_hi:[1,0,0]
    v_fma_mix_f32 v39, v25, 1.0, v81 op_sel:[0,0,0] op_sel_hi:[1,0,0]
    v_pk_mul_f32 v[36:37], v[36:37], v[86:87] op_sel_hi:[1,0]
    v_pk_mul_f32 v[38:39], v[38:39], v[86:87] op_sel_hi:[1,0]
    s_waitcnt lgkmcnt(0)
    v_fma_mix_f32 v26, v26, 1.0, v78 op_sel:[0,0,0] op_sel_hi:[1,0,0]
    v_mov_b32_dpp v42, v36 quad_perm:[0,0,0,0] row_mask:0x4 bank_mask:0xf
    v_cvt_pk_bf16_f32 v41, v39, v38
    s_mov_b32 exec_lo, s8
    s_mov_b32 exec_hi, s8
    v_mov_b32 v36, 0
    s_mov_b64 exec, -1
    ds_write_b32 v14, v41
    v_mul_f32 v26, v26, v86
    v_cvt_pk_bf16_f32 v40, v37, v36
    ds_write_b16 v3, v41
    v_pk_add_f16 v32, v32, v34
    v_pk_add_f16 v33, v33, v35
    ds_write_b16_d16_hi v3, v41 offset:2
    v_mov_b32_dpp v42, v26 quad_perm:[0,1,2,3] row_mask:0x2 bank_mask:0xf
    v_fma_mix_f32 v34, v32, v86, 0 op_sel:[1,0,0] op_sel_hi:[1,0,0]
    v_fma_mix_f32 v35, v33, v86, 0 op_sel:[0,0,0] op_sel_hi:[1,0,0]
    v_fma_mix_f32 v36, v33, v86, 0 op_sel:[1,0,0] op_sel_hi:[1,0,0]
    ds_write_b32 v12, v40
    v_mov_b32_dpp v42, v34 quad_perm:[0,1,2,3] row_mask:0x8 bank_mask:0x1
    ds_write_b16 v13, v40
    v_mov_b32_dpp v42, v35 quad_perm:[0,1,2,3] row_mask:0x8 bank_mask:0x2
    ds_write_b16_d16_hi v13, v40 offset:2
    v_mov_b32_dpp v42, v36 quad_perm:[0,1,2,3] row_mask:0x1 bank_mask:0xf
    v_cvt_pk_bf16_f32 v42, v42, v42
    ds_write_b16 v11, v42 offset:0
    ds_write_b16 v11, v42 offset:2110
    ds_write_b16 v11, v42 offset:4220
    ds_write_b16 v11, v42 offset:6330
    ds_write_b32 v1, v2 offset:12
    ds_read_b128 v[112:115], v19 offset:0
    ds_read_b128 v[116:119], v19 offset:1024
    ds_read_b128 v[120:123], v19 offset:2048
    ds_read_b128 v[124:127], v19 offset:3072
    ds_read_b64 v[60:61], v5 offset:1144
    ds_read_b64 v[62:63], v5 offset:1152
    s_setprio 3
L_w_l:
    ds_read_b32 v16, v1 offset:16
    ds_read_b32 v17, v1 offset:8
    s_waitcnt lgkmcnt(0)
    v_lshrrev_b32 v16, 2, v16
    v_and_b32 v16, v16, v17
    v_cmp_eq_u32 vcc, 0, v16
    s_cbranch_vccnz L_ws_l
L_wd_l:
    ds_read_b128 v[104:107], v4 offset:480
    ds_read_b128 v[108:111], v4 offset:464
    ds_read_b64 v[64:65], v5 offset:24
    ds_read_b64 v[66:67], v5 offset:32
    ds_read2_b32 v[20:21], v6 offset0:17 offset1:18
    ds_read2_b32 v[22:23], v6 offset0:49 offset1:50
    ds_read2_b32 v[24:25], v6 offset0:81 offset1:82
    ds_read2_b32 v[26:27], v6 offset0:113 offset1:114
    s_waitcnt lgkmcnt(7)
    v_mfma_f32_16x16x32_bf16 v[12:15], v[104:107], v[112:115], 0
    v_mfma_f32_16x16x32_bf16 v[16:19], v[104:107], v[116:119], 0
    s_waitcnt lgkmcnt(4)
    v_mfma_f32_16x16x32_bf16 v[68:71], v[64:67], v[104:107], 0
    ds_read2_b32 v[28:29], v6 offset0:9 offset1:10
    ds_read2_b32 v[30:31], v6 offset0:41 offset1:42
    ds_read2_b32 v[36:37], v6 offset0:1 offset1:2
    ds_read2_b32 v[38:39], v6 offset0:33 offset1:34
    ds_read2_b32 v[32:33], v6 offset0:73 offset1:74
    ds_read2_b32 v[34:35], v6 offset0:105 offset1:106
    v_mfma_f32_16x16x32_bf16 v[8:11], v[108:111], v[112:115], 0
    v_cvt_pk_bf16_f32 v92, v12, v13
    v_mfma_f32_16x16x32_bf16 v[56:59], v[108:111], v[116:119], 0
    v_cvt_pk_bf16_f32 v93, v14, v15
    v_mfma_f32_16x16x32_bf16 v[76:79], v[60:63], v[104:107], 0
    v_cvt_pk_bf16_f32 v94, v16, v17
    ds_read2_b32 v[40:41], v6 offset0:65 offset1:66
    ds_read2_b32 v[42:43], v6 offset0:97 offset1:98
    ds_read2_b32 v[84:85], v6 offset0:129 offset1:130
    ds_read2_b32 v[86:87], v6 offset0:169 offset1:170
    ds_read2_b32 v[44:45], v6 offset0:153 offset1:154
    ds_read2_b32 v[46:47], v6 offset0:193 offset1:194
    v_cvt_pk_bf16_f32 v95, v18, v19
    v_mfma_f32_16x16x32_bf16 v[12:15], v[104:107], v[120:123], 0
    v_cvt_pk_bf16_f32 v96, v8, v9
    v_mfma_f32_16x16x32_bf16 v[16:19], v[108:111], v[124:127], 0
    v_cvt_pk_bf16_f32 v97, v10, v11
    ds_read_b128 v[104:107], v4 offset:992
    ds_read_b128 v[108:111], v4 offset:976
    s_waitcnt lgkmcnt(15)
    v_mfma_f32_16x16x32_bf16 v[68:71], v[92:95], v[20:23], v[68:71]
    v_cvt_pk_bf16_f32 v98, v56, v57
    ds_read2_b32 v[48:49], v6 offset0:145 offset1:146
    ds_read2_b32 v[50:51], v6 offset0:185 offset1:186
    ds_read2_b32 v[52:53], v6 offset0:137 offset1:138
    ds_read2_b32 v[54:55], v6 offset0:177 offset1:178
    v_cvt_pk_bf16_f32 v99, v58, v59
    s_waitcnt lgkmcnt(5)
    v_mfma_f32_16x16x32_bf16 v[8:11], v[104:107], v[112:115], 0
    v_cvt_pk_bf16_f32 v100, v12, v13
    v_mfma_f32_16x16x32_bf16 v[56:59], v[104:107], v[116:119], 0
    v_cvt_pk_bf16_f32 v101, v14, v15
    v_mfma_f32_16x16x32_bf16 v[72:75], v[64:67], v[104:107], 0
    v_cvt_pk_bf16_f32 v102, v16, v17
    v_mfma_f32_16x16x32_bf16 v[68:71], v[96:99], v[24:27], v[68:71]
    v_cvt_pk_bf16_f32 v103, v18, v19
    v_mfma_f32_16x16x32_bf16 v[72:75], v[92:95], v[28:31], v[72:75]
    v_mfma_f32_16x16x32_bf16 v[76:79], v[92:95], v[36:39], v[76:79]
    s_nop 4
    ds_write_b128 v0, v[68:71] offset:0
    v_mov_b32 v2, 2
    s_waitcnt lgkmcnt(5)
    v_mfma_f32_16x16x32_bf16 v[12:15], v[108:111], v[112:115], 0
    ds_write_addtid_b32 v2 offset:10496
    v_mfma_f32_16x16x32_bf16 v[16:19], v[108:111], v[116:119], 0
    v_cvt_pk_bf16_f32 v92, v8, v9
    v_mfma_f32_16x16x32_bf16 v[80:83], v[60:63], v[104:107], 0
    v_cvt_pk_bf16_f32 v93, v10, v11
    v_mfma_f32_16x16x32_bf16 v[72:75], v[96:99], v[32:35], v[72:75]
    v_cvt_pk_bf16_f32 v94, v56, v57
    v_mfma_f32_16x16x32_bf16 v[76:79], v[96:99], v[40:43], v[76:79]
    v_cvt_pk_bf16_f32 v95, v58, v59
    v_mfma_f32_16x16x32_bf16 v[8:11], v[104:107], v[120:123], 0
    v_cvt_pk_bf16_f32 v96, v12, v13
    v_mfma_f32_16x16x32_bf16 v[56:59], v[108:111], v[124:127], 0
    v_cvt_pk_bf16_f32 v97, v14, v15
    ds_read_b128 v[104:107], v4 offset:1504
    ds_read_b128 v[108:111], v4 offset:1488
    v_mfma_f32_16x16x32_bf16 v[88:91], v[100:103], v[84:87], 0
    v_cvt_pk_bf16_f32 v98, v16, v17
    v_mfma_f32_16x16x32_bf16 v[76:79], v[100:103], v[44:47], v[76:79]
    v_cvt_pk_bf16_f32 v99, v18, v19
    s_waitcnt lgkmcnt(6)
    v_mfma_f32_16x16x32_bf16 v[80:83], v[100:103], v[48:51], v[80:83]
    s_waitcnt lgkmcnt(4)
    v_mfma_f32_16x16x32_bf16 v[84:87], v[100:103], v[52:55], 0
    v_mfma_f32_16x16x32_bf16 v[72:75], v[92:95], v[20:23], v[72:75]
    s_setprio 2
    s_waitcnt lgkmcnt(1)
    v_mfma_f32_16x16x32_bf16 v[12:15], v[104:107], v[112:115], 0
    v_cvt_pk_bf16_f32 v100, v8, v9
    v_mfma_f32_16x16x32_bf16 v[16:19], v[104:107], v[116:119], 0
    v_cvt_pk_bf16_f32 v101, v10, v11
    v_mfma_f32_16x16x32_bf16 v[76:79], v[64:67], v[104:107], v[76:79]
    v_cvt_pk_bf16_f32 v102, v56, v57
    v_mfma_f32_16x16x32_bf16 v[72:75], v[96:99], v[24:27], v[72:75]
    v_cvt_pk_bf16_f32 v103, v58, v59
    v_mfma_f32_16x16x32_bf16 v[76:79], v[92:95], v[28:31], v[76:79]
    v_mfma_f32_16x16x32_bf16 v[80:83], v[92:95], v[36:39], v[80:83]
    s_nop 4
    ds_write_b128 v0, v[72:75] offset:1024
    v_mov_b32 v2, 3
    s_waitcnt lgkmcnt(1)
    v_mfma_f32_16x16x32_bf16 v[8:11], v[108:111], v[112:115], 0
    ds_write_addtid_b32 v2 offset:10496
    v_mfma_f32_16x16x32_bf16 v[56:59], v[108:111], v[116:119], 0
    v_cvt_pk_bf16_f32 v92, v12, v13
    v_mfma_f32_16x16x32_bf16 v[84:87], v[60:63], v[104:107], v[84:87]
    v_cvt_pk_bf16_f32 v93, v14, v15
    v_mfma_f32_16x16x32_bf16 v[76:79], v[96:99], v[32:35], v[76:79]
    v_cvt_pk_bf16_f32 v94, v16, v17
    v_mfma_f32_16x16x32_bf16 v[80:83], v[96:99], v[40:43], v[80:83]
    v_cvt_pk_bf16_f32 v95, v18, v19
    v_mfma_f32_16x16x32_bf16 v[12:15], v[104:107], v[120:123], 0
    v_cvt_pk_bf16_f32 v96, v8, v9
    v_mfma_f32_16x16x32_bf16 v[16:19], v[108:111], v[124:127], 0
    v_cvt_pk_bf16_f32 v97, v10, v11
    ds_read_b128 v[104:107], v4 offset:2016
    ds_read_b128 v[108:111], v4 offset:2000
    v_mfma_f32_16x16x32_bf16 v[80:83], v[100:103], v[44:47], v[80:83]
    v_cvt_pk_bf16_f32 v98, v56, v57
    v_mfma_f32_16x16x32_bf16 v[84:87], v[100:103], v[48:51], v[84:87]
    v_cvt_pk_bf16_f32 v99, v58, v59
    v_mfma_f32_16x16x32_bf16 v[88:91], v[100:103], v[52:55], v[88:91]
    v_mfma_f32_16x16x32_bf16 v[76:79], v[92:95], v[20:23], v[76:79]
    s_waitcnt lgkmcnt(1)
    v_mfma_f32_16x16x32_bf16 v[8:11], v[104:107], v[112:115], 0
    v_cvt_pk_bf16_f32 v100, v12, v13
    v_mfma_f32_16x16x32_bf16 v[56:59], v[104:107], v[116:119], 0
    v_cvt_pk_bf16_f32 v101, v14, v15
    v_mfma_f32_16x16x32_bf16 v[80:83], v[64:67], v[104:107], v[80:83]
    v_cvt_pk_bf16_f32 v102, v16, v17
    ds_read_b32 v7, v1 offset:20
    v_mfma_f32_16x16x32_bf16 v[76:79], v[96:99], v[24:27], v[76:79]
    v_cvt_pk_bf16_f32 v103, v18, v19
    v_mfma_f32_16x16x32_bf16 v[80:83], v[92:95], v[28:31], v[80:83]
    v_mfma_f32_16x16x32_bf16 v[84:87], v[92:95], v[36:39], v[84:87]
    s_nop 4
    ds_write_b128 v0, v[76:79] offset:2048
    v_mov_b32 v2, 4
    s_waitcnt lgkmcnt(2)
    v_mfma_f32_16x16x32_bf16 v[12:15], v[108:111], v[112:115], 0
    ds_write_addtid_b32 v2 offset:10496
    v_mfma_f32_16x16x32_bf16 v[16:19], v[108:111], v[116:119], 0
    v_cvt_pk_bf16_f32 v92, v8, v9
    v_mfma_f32_16x16x32_bf16 v[88:91], v[60:63], v[104:107], v[88:91]
    v_cvt_pk_bf16_f32 v93, v10, v11
    v_mfma_f32_16x16x32_bf16 v[80:83], v[96:99], v[32:35], v[80:83]
    v_cvt_pk_bf16_f32 v94, v56, v57
    v_mfma_f32_16x16x32_bf16 v[84:87], v[96:99], v[40:43], v[84:87]
    v_cvt_pk_bf16_f32 v95, v58, v59
    v_mfma_f32_16x16x32_bf16 v[8:11], v[104:107], v[120:123], 0
    v_cvt_pk_bf16_f32 v96, v12, v13
    v_mfma_f32_16x16x32_bf16 v[56:59], v[108:111], v[124:127], 0
    v_cvt_pk_bf16_f32 v97, v14, v15
    s_waitcnt lgkmcnt(2)
    v_cmp_gt_u32 vcc, 4, v7
    s_cbranch_vccnz L_sp_lu4
L_ok_lu4:
    ds_read_b128 v[104:107], v4 offset:2528
    ds_read_b128 v[108:111], v4 offset:2512
    v_mfma_f32_16x16x32_bf16 v[84:87], v[100:103], v[44:47], v[84:87]
    v_cvt_pk_bf16_f32 v98, v16, v17
    v_mfma_f32_16x16x32_bf16 v[88:91], v[100:103], v[48:51], v[88:91]
    v_cvt_pk_bf16_f32 v99, v18, v19
    v_mfma_f32_16x16x32_bf16 v[80:83], v[92:95], v[20:23], v[80:83]
    s_setprio 1
    s_waitcnt lgkmcnt(1)
    v_mfma_f32_16x16x32_bf16 v[12:15], v[104:107], v[112:115], 0
    v_cvt_pk_bf16_f32 v100, v8, v9
    v_mfma_f32_16x16x32_bf16 v[16:19], v[104:107], v[116:119], 0
    v_cvt_pk_bf16_f32 v101, v10, v11
    v_mfma_f32_16x16x32_bf16 v[84:87], v[64:67], v[104:107], v[84:87]
    v_cvt_pk_bf16_f32 v102, v56, v57
    v_mfma_f32_16x16x32_bf16 v[80:83], v[96:99], v[24:27], v[80:83]
    v_cvt_pk_bf16_f32 v103, v58, v59
    v_mfma_f32_16x16x32_bf16 v[84:87], v[92:95], v[28:31], v[84:87]
    v_mfma_f32_16x16x32_bf16 v[88:91], v[92:95], v[36:39], v[88:91]
    s_nop 4
    ds_write_b128 v0, v[80:83] offset:3072
    v_mov_b32 v2, 5
    s_waitcnt lgkmcnt(1)
    v_mfma_f32_16x16x32_bf16 v[8:11], v[108:111], v[112:115], 0
    ds_write_addtid_b32 v2 offset:10496
    v_mfma_f32_16x16x32_bf16 v[56:59], v[108:111], v[116:119], 0
    v_cvt_pk_bf16_f32 v92, v12, v13
    ds_read_b128 v[104:107], v4 offset:3040
    ds_read_b128 v[108:111], v4 offset:3024
    v_mfma_f32_16x16x32_bf16 v[84:87], v[96:99], v[32:35], v[84:87]
    v_cvt_pk_bf16_f32 v93, v14, v15
    v_mfma_f32_16x16x32_bf16 v[88:91], v[96:99], v[40:43], v[88:91]
    v_cvt_pk_bf16_f32 v94, v16, v17
    v_mfma_f32_16x16x32_bf16 v[88:91], v[100:103], v[44:47], v[88:91]
    v_cvt_pk_bf16_f32 v95, v18, v19
    s_nop 1
    v_mfma_f32_16x16x32_bf16 v[84:87], v[92:95], v[20:23], v[84:87]
    v_cvt_pk_bf16_f32 v96, v8, v9
    s_waitcnt lgkmcnt(1)
    v_mfma_f32_16x16x32_bf16 v[12:15], v[104:107], v[112:115], 0
    v_cvt_pk_bf16_f32 v97, v10, v11
    v_mfma_f32_16x16x32_bf16 v[16:19], v[104:107], v[116:119], 0
    v_cvt_pk_bf16_f32 v98, v56, v57
    v_mfma_f32_16x16x32_bf16 v[88:91], v[64:67], v[104:107], v[88:91]
    v_cvt_pk_bf16_f32 v99, v58, v59
    s_nop 1
    v_mfma_f32_16x16x32_bf16 v[84:87], v[96:99], v[24:27], v[84:87]
    v_mfma_f32_16x16x32_bf16 v[88:91], v[92:95], v[28:31], v[88:91]
    s_nop 6
    ds_write_b128 v0, v[84:87] offset:4096
    v_mov_b32 v2, 6
    ds_write_addtid_b32 v2 offset:10496
    s_setprio 0
    s_waitcnt lgkmcnt(2)
    v_mfma_f32_16x16x32_bf16 v[8:11], v[108:111], v[112:115], 0
    v_cvt_pk_bf16_f32 v92, v12, v13
    v_mfma_f32_16x16x32_bf16 v[56:59], v[108:111], v[116:119], 0
    v_cvt_pk_bf16_f32 v93, v14, v15
    v_mfma_f32_16x16x32_bf16 v[88:91], v[96:99], v[32:35], v[88:91]
    v_cvt_pk_bf16_f32 v94, v16, v17
    v_cvt_pk_bf16_f32 v95, v18, v19
    s_nop 1
    v_mfma_f32_16x16x32_bf16 v[88:91], v[92:95], v[20:23], v[88:91]
    v_cvt_pk_bf16_f32 v96, v8, v9
    s_setprio 0
    v_cvt_pk_bf16_f32 v97, v10, v11
    v_cvt_pk_bf16_f32 v98, v56, v57
    v_cvt_pk_bf16_f32 v99, v58, v59
    s_nop 1
    v_mfma_f32_16x16x32_bf16 v[88:91], v[96:99], v[24:27], v[88:91]
    s_nop 7
    ds_write_b128 v0, v[88:91] offset:5120
    v_mov_b32 v2, 7
    ds_write_addtid_b32 v2 offset:10496
    s_branch L_fin
    .p2align 6
L_mem0:
    s_load_dwordx2 s[32:33], s[0:1], 112
    s_setprio 3
    s_mov_b32 s45, s44
    s_bitcmp1_b32 s2, 2
    s_cselect_b32 s48, 1152, 0
    v_mov_b32 v8, 0
    v_mov_b32 v9, 0
    v_mov_b32 v10, 0
    v_mov_b32 v11, 0
    v_lshlrev_b32 v17, 4, v1
    ds_write_b128 v17, v[8:11] offset:64512
    v_min_u32 v5, 5, v1
    v_min_u32 v16, s43, v1
    v_mul_u32_u24 v16, 10752, v16
    ds_write_b32 v16, v8 offset:10240
    ds_write_b32 v16, v8 offset:10496
    s_mul_i32 s8, s45, 12672
    s_add_u32 s8, s8, 65536
    v_add_u32 v7, s8, v17
    ds_write_b128 v7, v[8:11] offset:1024
    ds_write_b128 v7, v[8:11] offset:3136
    ds_write_b128 v7, v[8:11] offset:5248
    ds_write_b128 v7, v[8:11] offset:7360
    ds_write_b128 v7, v[8:11] offset:9472
    ds_write_b128 v7, v[8:11] offset:11584
    v_lshrrev_b32 v7, 2, v1
    v_min_u32 v7, 5, v7
    v_mul_u32_u24 v7, 2112, v7
    v_and_b32 v6, 48, v17
    v_add3_u32 v7, v7, v6, s8
    ds_write_b128 v7, v[8:11]
    v_lshrrev_b32 v7, 5, v1
    s_lshl_b32 s8, s45, 1
    v_add_u32 v7, s8, v7
    v_min_u32 v7, 5, v7
    v_mul_u32_u24 v7, 4608, v7
    v_and_b32 v6, 31, v1
    v_lshl_add_u32 v6, v6, 4, v7
    v_add_u32 v6, 116224, v6
    ds_write_b128 v6, v[8:11]
    s_getpc_b64 s[52:53]
L_pc2:
    s_add_u32 s52, s52, L_table-L_pc2
    s_addc_u32 s53, s53, 0
    s_lshl_b32 s8, s45, 11
    v_add_u32 v17, s8, v17
    s_add_u32 s8, s8, 143872
    s_mov_b32 m0, s8
    v_lshlrev_b32 v6, 7, v5
    v_and_b32 v4, 15, v1
    v_lshrrev_b32 v15, 4, v1
    s_lshl_b32 s47, s5, 1
    s_mul_i32 s9, s45, 294912
    s_add_u32 s9, s9, s47
    v_mul_u32_u24 v19, 4608, v1
    s_add_u32 s48, s48, s47
    s_mov_b32 s34, 4718592
    s_mov_b32 s35, 0x00020000
    s_mov_b32 s50, 0x05040100
    s_mov_b32 s51, 0x07060302
    s_mov_b32 s36, 0x40000
    v_lshl_add_u32 v4, v4, 2, v15
    v_mul_u32_u24 v18, 9216, v4
    s_mul_i32 s8, s45, 512
    s_add_u32 s8, s8, 116736
    v_lshl_add_u32 v3, v1, 3, s8
    v_add_u32 v18, s48, v18
    v_mov_b32 v2, 1
    s_and_b32 s8, s45, 1
    s_mul_i32 s57, s8, 4608
    s_mov_b32 s56, 1
    s_lshl_b32 s8, s8, 8
    s_add_u32 s8, s8, 6144
    v_lshl_add_u32 v4, v1, 2, s8
    s_waitcnt lgkmcnt(0)
    s_mov_b32 s18, 2359296
    s_mov_b32 s19, 0x00020000
    s_barrier
    global_load_lds_dwordx4 v17, s[52:53]
    global_load_lds_dwordx4 v17, s[52:53] offset:1024
    s_cmp_eq_u32 s43, 3
    s_cbranch_scc1 L_ul2
    buffer_load_dwordx3 v[20:22], v19, s[16:19], s9 offen offset:0
    buffer_load_dwordx3 v[24:26], v19, s[16:19], s9 offen offset:1152
    buffer_load_dwordx3 v[28:30], v19, s[16:19], s9 offen offset:2304
    buffer_load_dwordx3 v[32:34], v19, s[16:19], s9 offen offset:3456
    s_add_u32 s9, s9, 1179648
    s_mov_b64 exec, 63
    s_waitcnt vmcnt(4)
    ds_add_u32 v6, v2 offset:64612
    s_mov_b64 exec, -1
    buffer_load_dwordx3 v[36:38], v19, s[16:19], s9 offen offset:0
    buffer_load_dwordx3 v[40:42], v19, s[16:19], s9 offen offset:1152
    buffer_load_dwordx3 v[44:46], v19, s[16:19], s9 offen offset:2304
    buffer_load_dwordx3 v[48:50], v19, s[16:19], s9 offen offset:3456
    s_branch L_uld
L_ul2:
    buffer_load_dwordx2 v[20:21], v19, s[16:19], s9 offen offset:0
    buffer_load_dwordx2 v[24:25], v19, s[16:19], s9 offen offset:1152
    buffer_load_dwordx2 v[28:29], v19, s[16:19], s9 offen offset:2304
    buffer_load_dwordx2 v[32:33], v19, s[16:19], s9 offen offset:3456
    s_add_u32 s9, s9, 1179648
    s_mov_b64 exec, 63
    s_waitcnt vmcnt(4)
    ds_add_u32 v6, v2 offset:64612
    s_mov_b64 exec, -1
    buffer_load_dwordx2 v[36:37], v19, s[16:19], s9 offen offset:0
    buffer_load_dwordx2 v[40:41], v19, s[16:19], s9 offen offset:1152
    buffer_load_dwordx2 v[44:45], v19, s[16:19], s9 offen offset:2304
    buffer_load_dwordx2 v[48:49], v19, s[16:19], s9 offen offset:3456
L_uld:
    s_waitcnt vmcnt(4)
    v_perm_b32 v88, v24, v20, s50
    v_perm_b32 v89, v32, v28, s50
    ds_write_b64 v3, v[88:89] offset:0
    v_perm_b32 v90, v24, v20, s51
    v_perm_b32 v91, v32, v28, s51
    ds_write_b64 v3, v[90:91] offset:4608
    v_perm_b32 v92, v25, v21, s50
    v_perm_b32 v93, v33, v29, s50
    ds_write_b64 v3, v[92:93] offset:9216
    v_perm_b32 v94, v25, v21, s51
    v_perm_b32 v95, v33, v29, s51
    ds_write_b64 v3, v[94:95] offset:13824
    s_cmp_eq_u32 s43, 3
    s_cbranch_scc1 L_tp0
    v_perm_b32 v88, v26, v22, s50
    v_perm_b32 v89, v34, v30, s50
    ds_write_b64 v3, v[88:89] offset:18432
    v_perm_b32 v90, v26, v22, s51
    v_perm_b32 v91, v34, v30, s51
    ds_write_b64 v3, v[90:91] offset:23040
L_tp0:
    s_mov_b64 exec, 63
    ds_add_u32 v6, v2 offset:64528
    s_mov_b64 exec, -1
    v_mov_b32 v8, 0
    s_cmp_eq_u32 s43, 3
    s_cselect_b32 s37, 3, 1
    s_cmp_ge_u32 s45, 2
    s_cbranch_scc1 L_mpoll
    s_mov_b32 s56, 100
    s_waitcnt vmcnt(0)
L_mu2:
    s_cmp_eq_u32 s43, 3
    s_cbranch_scc1 L_mw4
    s_waitcnt vmcnt(0)
L_mw4:
    s_waitcnt vmcnt(4)
    v_perm_b32 v88, v40, v36, s50
    v_perm_b32 v89, v48, v44, s50
    ds_write_b64 v3, v[88:89] offset:2048
    v_perm_b32 v90, v40, v36, s51
    v_perm_b32 v91, v48, v44, s51
    ds_write_b64 v3, v[90:91] offset:6656
    v_perm_b32 v92, v41, v37, s50
    v_perm_b32 v93, v49, v45, s50
    ds_write_b64 v3, v[92:93] offset:11264
    v_perm_b32 v94, v41, v37, s51
    v_perm_b32 v95, v49, v45, s51
    ds_write_b64 v3, v[94:95] offset:15872
    s_cmp_eq_u32 s43, 3
    s_cbranch_scc1 L_tp1
    v_perm_b32 v88, v42, v38, s50
    v_perm_b32 v89, v50, v46, s50
    ds_write_b64 v3, v[88:89] offset:20480
    v_perm_b32 v90, v42, v38, s51
    v_perm_b32 v91, v50, v46, s51
    ds_write_b64 v3, v[90:91] offset:25088
L_tp1:
    s_mov_b64 exec, 63
    ds_add_u32 v6, v2 offset:64532
    s_mov_b64 exec, -1
    s_cmp_eq_u32 s56, 100
    s_cbranch_scc1 L_fin
    s_mov_b32 s37, 0
L_mpoll:
    s_cmp_eq_u32 s56, s37
    s_cbranch_scc1 L_mu2
L_mpoll2:
    ds_read_b32 v8, v16 offset:10240
    s_waitcnt lgkmcnt(0)
    v_cmp_gt_u32 vcc, s56, v8
    s_cbranch_vccz L_mgo
    s_sleep 1
    s_sub_u32 s36, s36, 1
    s_cbranch_scc0 L_mpoll2
L_mgo:
    ds_read_b32 v96, v4 offset:0
    ds_read_b32 v97, v4 offset:10752
    ds_read_b32 v98, v4 offset:21504
    ds_read_b32 v99, v4 offset:32256
    ds_read_b32 v100, v4 offset:43008
    ds_read_b32 v101, v4 offset:53760
    v_add_u32 v4, 512, v4
    s_waitcnt lgkmcnt(4)
    v_perm_b32 v104, v97, v96, s50
    s_waitcnt lgkmcnt(2)
    v_perm_b32 v105, v99, v98, s50
    s_waitcnt lgkmcnt(0)
    v_perm_b32 v106, v101, v100, s50
    v_perm_b32 v108, v97, v96, s51
    v_perm_b32 v109, v99, v98, s51
    v_perm_b32 v110, v101, v100, s51
    s_cmp_eq_u32 s43, 3
    s_cbranch_scc1 L_st2
    buffer_store_dwordx3 v[104:106], v18, s[32:35], s57 offen
    buffer_store_dwordx3 v[108:110], v18, s[32:35], s57 offen offset:2304
    s_branch L_std
L_st2:
    buffer_store_dwordx2 v[104:105], v18, s[32:35], s57 offen
    buffer_store_dwordx2 v[108:109], v18, s[32:35], s57 offen offset:2304
L_std:
    s_add_u32 s57, s57, 589824
    s_add_u32 s56, s56, 1
    s_cmp_le_u32 s56, 8
    s_cbranch_scc1 L_mpoll
L_fin:
L_end:
    s_endpgm
L_tws:
    s_sleep 1
    s_waitcnt lgkmcnt(0)
    s_sub_u32 s34, s34, 1
    s_cbranch_scc0 L_tw
    s_branch L_twd
L_ws_pxd:
    s_sleep 1
    s_sub_u32 s34, s34, 1
    s_cbranch_scc0 L_w_pxd
    s_branch L_wd_pxd
L_ws_d:
    s_sleep 1
    s_sub_u32 s34, s34, 1
    s_cbranch_scc0 L_w_d
    s_branch L_wd_d
L_sp_kl:
    s_sleep 1
    ds_read_b32 v18, v1 offset:12
    s_waitcnt lgkmcnt(0)
    s_sub_u32 s34, s34, 1
    s_cbranch_scc1 L_ok_kl
    v_cmp_eq_u32 vcc, 0, v18
    s_cbranch_vccnz L_sp_kl
    s_branch L_ok_kl
L_sp_p2:
    s_sleep 1
    ds_read_addtid_b32 v18 offset:10496
    ds_read_b128 v[12:15], v0 offset:0
    s_waitcnt lgkmcnt(0)
    s_sub_u32 s34, s34, 1
    s_cbranch_scc1 L_ok_p2
    v_cmp_gt_u32 vcc, 2, v18
    s_cbranch_vccnz L_sp_p2
    s_branch L_ok_p2
L_sp_p3:
    s_sleep 1
    ds_read_addtid_b32 v18 offset:10496
    ds_read_b128 v[12:15], v0 offset:1024
    s_waitcnt lgkmcnt(0)
    s_sub_u32 s34, s34, 1
    s_cbranch_scc1 L_ok_p3
    v_cmp_gt_u32 vcc, 3, v18
    s_cbranch_vccnz L_sp_p3
    s_branch L_ok_p3
L_sp_du4:
    s_sleep 1
    ds_read_b32 v10, v1 offset:20
    s_waitcnt lgkmcnt(0)
    s_sub_u32 s34, s34, 1
    s_cbranch_scc1 L_ok_du4
    v_cmp_gt_u32 vcc, 4, v10
    s_cbranch_vccnz L_sp_du4
    s_branch L_ok_du4
L_sp_p4:
    s_sleep 1
    ds_read_addtid_b32 v18 offset:10496
    ds_read_b128 v[12:15], v0 offset:2048
    s_waitcnt lgkmcnt(0)
    s_sub_u32 s34, s34, 1
    s_cbranch_scc1 L_ok_p4
    v_cmp_gt_u32 vcc, 4, v18
    s_cbranch_vccnz L_sp_p4
    s_branch L_ok_p4
L_sp_p5:
    s_sleep 1
    ds_read_addtid_b32 v18 offset:10496
    ds_read_b128 v[12:15], v0 offset:3072
    s_waitcnt lgkmcnt(0)
    s_sub_u32 s34, s34, 1
    s_cbranch_scc1 L_ok_p5
    v_cmp_gt_u32 vcc, 5, v18
    s_cbranch_vccnz L_sp_p5
    s_branch L_ok_p5
L_sp_p6:
    s_sleep 1
    ds_read_addtid_b32 v18 offset:10496
    ds_read_b128 v[12:15], v0 offset:4096
    s_waitcnt lgkmcnt(0)
    s_sub_u32 s34, s34, 1
    s_cbranch_scc1 L_ok_p6
    v_cmp_gt_u32 vcc, 6, v18
    s_cbranch_vccnz L_sp_p6
    s_branch L_ok_p6
L_sp_p7:
    s_sleep 1
    ds_read_addtid_b32 v18 offset:10496
    ds_read_b128 v[12:15], v0 offset:5120
    s_waitcnt lgkmcnt(0)
    s_sub_u32 s34, s34, 1
    s_cbranch_scc1 L_ok_p7
    v_cmp_gt_u32 vcc, 7, v18
    s_cbranch_vccnz L_sp_p7
    s_branch L_ok_p7
L_ws_pxl:
    s_sleep 1
    s_sub_u32 s34, s34, 1
    s_cbranch_scc0 L_w_pxl
    s_branch L_wd_pxl
L_ws_l:
    s_sleep 1
    s_sub_u32 s34, s34, 1
    s_cbranch_scc0 L_w_l
    s_branch L_wd_l
L_sp_lu4:
    s_sleep 1
    ds_read_b32 v7, v1 offset:20
    s_waitcnt lgkmcnt(0)
    s_sub_u32 s34, s34, 1
    s_cbranch_scc1 L_ok_lu4
    v_cmp_gt_u32 vcc, 4, v7
    s_cbranch_vccnz L_sp_lu4
    s_branch L_ok_lu4
L_codeend:
.p2align 7
.type L_table,@object
L_table:
.long 0x0, 0x0, 0x0, 0x0
.long 0x0, 0x0, 0x0, 0x0
.long 0x0, 0x0, 0x0, 0x0
.long 0x0, 0x0, 0x0, 0x0
.long 0x0, 0x0, 0x0, 0x0
.long 0x0, 0x0, 0x0, 0x0
.long 0x0, 0x0, 0x0, 0x0
.long 0x0, 0x0, 0x0, 0x0
.long 0x0, 0x0, 0x0, 0x0
.long 0x0, 0x0, 0x0, 0x0
.long 0x0, 0x0, 0x0, 0x0
.long 0x0, 0x0, 0x0, 0x0
.long 0x0, 0x0, 0x0, 0x0
.long 0x0, 0x0, 0x0, 0x0
.long 0x0, 0x0, 0x0, 0x0
.long 0x0, 0x0, 0x0, 0x0
.long 0x0, 0x3f800000, 0x3f803f80, 0x0
.long 0x0, 0x0, 0x3f803f80, 0x3f80
.long 0x0, 0x0, 0x3f800000, 0x3f803f80
.long 0x0, 0x0, 0x0, 0x3f803f80
.long 0x0, 0x0, 0x0, 0x3f800000
.long 0x0, 0x0, 0x0, 0x0
.long 0x0, 0x0, 0x0, 0x0
.long 0x0, 0x0, 0x0, 0x0
.long 0x0, 0x0, 0x0, 0x0
.long 0x0, 0x0, 0x0, 0x0
.long 0x0, 0x0, 0x0, 0x0
.long 0x0, 0x0, 0x0, 0x0
.long 0x0, 0x0, 0x0, 0x0
.long 0x0, 0x0, 0x0, 0x0
.long 0x0, 0x0, 0x0, 0x0
.long 0x0, 0x0, 0x0, 0x0
.long 0x0, 0x0, 0x0, 0x0
.long 0x0, 0x0, 0x0, 0x0
.long 0x0, 0x0, 0x0, 0x0
.long 0x3f80, 0x0, 0x0, 0x0
.long 0x3f803f80, 0x0, 0x0, 0x0
.long 0x3f803f80, 0x3f80, 0x0, 0x0
.long 0x3f800000, 0x3f803f80, 0x0, 0x0
.long 0x0, 0x3f803f80, 0x3f80, 0x0
.long 0x0, 0x3f800000, 0x3f803f80, 0x0
.long 0x0, 0x0, 0x3f803f80, 0x3f80
.long 0x0, 0x0, 0x3f800000, 0x3f803f80
.long 0x0, 0x0, 0x0, 0x3f803f80
.long 0x0, 0x0, 0x0, 0x3f800000
.long 0x0, 0x0, 0x0, 0x0
.long 0x0, 0x0, 0x0, 0x0
.long 0x0, 0x0, 0x0, 0x0
.long 0x0, 0x0, 0x0, 0x0
.long 0x0, 0x0, 0x0, 0x0
.long 0x0, 0x0, 0x0, 0x0
.long 0x0, 0x0, 0x0, 0x0
.long 0x0, 0x0, 0x0, 0x0
.long 0x0, 0x0, 0x0, 0x0
.long 0x0, 0x0, 0x0, 0x0
.long 0x0, 0x0, 0x0, 0x0
.long 0x0, 0x0, 0x0, 0x0
.long 0x0, 0x0, 0x0, 0x0
.long 0x0, 0x0, 0x0, 0x0
.long 0x3f80, 0x0, 0x0, 0x0
.long 0x3f803f80, 0x0, 0x0, 0x0
.long 0x3f803f80, 0x3f80, 0x0, 0x0
.long 0x3f800000, 0x3f803f80, 0x0, 0x0
.long 0x0, 0x3f803f80, 0x3f80, 0x0
.long 0x0, 0x0, 0x0, 0x3f803f80
.long 0x0, 0x0, 0x0, 0x3f800000
.long 0x0, 0x0, 0x0, 0x0
.long 0x0, 0x0, 0x0, 0x0
.long 0x0, 0x0, 0x0, 0x0
.long 0x0, 0x0, 0x0, 0x0
.long 0x0, 0x0, 0x0, 0x0
.long 0x0, 0x0, 0x0, 0x0
.long 0x0, 0x0, 0x0, 0x0
.long 0x0, 0x0, 0x0, 0x0
.long 0x0, 0x0, 0x0, 0x0
.long 0x0, 0x0, 0x0, 0x0
.long 0x0, 0x0, 0x0, 0x0
.long 0x0, 0x0, 0x0, 0x0
.long 0x0, 0x0, 0x0, 0x0
.long 0x0, 0x0, 0x0, 0x0
.long 0x3f803f80, 0x3f80, 0x0, 0x0
.long 0x3f803f80, 0x3f803f80, 0x0, 0x0
.long 0x3f803f80, 0x3f803f80, 0x3f80, 0x0
.long 0x3f800000, 0x3f803f80, 0x3f803f80, 0x0
.long 0x0, 0x3f803f80, 0x3f803f80, 0x3f80
.long 0x0, 0x3f800000, 0x3f803f80, 0x3f803f80
.long 0x0, 0x0, 0x3f803f80, 0x3f803f80
.long 0x0, 0x0, 0x3f800000, 0x3f803f80
.long 0x0, 0x0, 0x0, 0x3f803f80
.long 0x0, 0x0, 0x0, 0x3f800000
.long 0x0, 0x0, 0x0, 0x0
.long 0x0, 0x0, 0x0, 0x0
.long 0x0, 0x0, 0x0, 0x0
.long 0x0, 0x0, 0x0, 0x0
.long 0x0, 0x0, 0x0, 0x0
.long 0x0, 0x0, 0x0, 0x0
.long 0x0, 0x0, 0x0, 0x0
.long 0x0, 0x0, 0x0, 0x0
.long 0x0, 0x0, 0x0, 0x0
.long 0x0, 0x0, 0x0, 0x0
.long 0x0, 0x0, 0x0, 0x0
.long 0x0, 0x0, 0x0, 0x0
.long 0x3f80, 0x0, 0x0, 0x0
.long 0x3f803f80, 0x0, 0x0, 0x0
.long 0x3f803f80, 0x3f80, 0x0, 0x0
.long 0x3f803f80, 0x3f803f80, 0x0, 0x0
.long 0x3f803f80, 0x3f803f80, 0x3f80, 0x0
.long 0x3f800000, 0x3f803f80, 0x3f803f80, 0x0
.long 0x0, 0x3f803f80, 0x3f803f80, 0x3f80
.long 0x0, 0x3f800000, 0x3f803f80, 0x3f803f80
.long 0x0, 0x0, 0x3f803f80, 0x3f803f80
.long 0x0, 0x0, 0x3f800000, 0x3f803f80
.long 0x0, 0x0, 0x0, 0x0
.long 0x0, 0x0, 0x0, 0x0
.long 0x0, 0x0, 0x0, 0x0
.long 0x0, 0x0, 0x0, 0x0
.long 0x0, 0x0, 0x0, 0x0
.long 0x0, 0x0, 0x0, 0x0
.long 0x0, 0x0, 0x0, 0x0
.long 0x0, 0x0, 0x0, 0x0
.long 0x0, 0x0, 0x0, 0x0
.long 0x0, 0x0, 0x0, 0x0
.long 0x0, 0x0, 0x0, 0x0
.long 0x0, 0x0, 0x0, 0x0
.long 0x0, 0x0, 0x0, 0x0
.long 0x0, 0x0, 0x0, 0x0
.long 0x3f80, 0x0, 0x0, 0x0
.long 0x3f803f80, 0x0, 0x0, 0x0
.long 0x0, 0x0, 0x3f800000, 0x3f803f80
.long 0x0, 0x0, 0x0, 0x3f803f80
.long 0x0, 0x0, 0x0, 0x3f800000
.long 0x0, 0x0, 0x0, 0x0
.long 0x0, 0x0, 0x0, 0x0
.long 0x0, 0x0, 0x0, 0x0
.long 0x0, 0x0, 0x0, 0x0
.long 0x0, 0x0, 0x0, 0x0
.long 0x0, 0x0, 0x0, 0x0
.long 0x0, 0x0, 0x0, 0x0
.long 0x0, 0x0, 0x0, 0x0
.long 0x0, 0x0, 0x0, 0x0
.long 0x0, 0x0, 0x0, 0x0
.long 0x0, 0x0, 0x0, 0x0
.long 0x0, 0x0, 0x0, 0x0
.long 0x0, 0x0, 0x0, 0x0
.long 0x3f803f80, 0x3f803f80, 0x0, 0x0
.long 0x3f803f80, 0x3f803f80, 0x3f80, 0x0
.long 0x3f803f80, 0x3f803f80, 0x3f803f80, 0x0
.long 0x3f803f80, 0x3f803f80, 0x3f803f80, 0x3f80
.long 0x3f800000, 0x3f803f80, 0x3f803f80, 0x3f803f80
.long 0x0, 0x3f803f80, 0x3f803f80, 0x3f803f80
.long 0x0, 0x3f800000, 0x3f803f80, 0x3f803f80
.long 0x0, 0x0, 0x3f803f80, 0x3f803f80
.long 0x0, 0x0, 0x3f800000, 0x3f803f80
.long 0x0, 0x0, 0x0, 0x3f803f80
.long 0x0, 0x0, 0x0, 0x3f800000
.long 0x0, 0x0, 0x0, 0x0
.long 0x0, 0x0, 0x0, 0x0
.long 0x0, 0x0, 0x0, 0x0
.long 0x0, 0x0, 0x0, 0x0
.long 0x0, 0x0, 0x0, 0x0
.long 0x0, 0x0, 0x0, 0x0
.long 0x0, 0x0, 0x0, 0x0
.long 0x0, 0x0, 0x0, 0x0
.long 0x0, 0x0, 0x0, 0x0
.long 0x0, 0x0, 0x0, 0x0
.long 0x3f80, 0x0, 0x0, 0x0
.long 0x3f803f80, 0x0, 0x0, 0x0
.long 0x3f803f80, 0x3f80, 0x0, 0x0
.long 0x3f803f80, 0x3f803f80, 0x0, 0x0
.long 0x3f803f80, 0x3f803f80, 0x3f80, 0x0
.long 0x3f803f80, 0x3f803f80, 0x3f803f80, 0x0
.long 0x3f803f80, 0x3f803f80, 0x3f803f80, 0x3f80
.long 0x3f800000, 0x3f803f80, 0x3f803f80, 0x3f803f80
.long 0x0, 0x3f803f80, 0x3f803f80, 0x3f803f80
.long 0x0, 0x3f800000, 0x3f803f80, 0x3f803f80
.long 0x0, 0x0, 0x3f803f80, 0x3f803f80
.long 0x0, 0x0, 0x0, 0x0
.long 0x0, 0x0, 0x0, 0x0
.long 0x0, 0x0, 0x0, 0x0
.long 0x0, 0x0, 0x0, 0x0
.long 0x0, 0x0, 0x0, 0x0
.long 0x0, 0x0, 0x0, 0x0
.long 0x0, 0x0, 0x0, 0x0
.long 0x0, 0x0, 0x0, 0x0
.long 0x0, 0x0, 0x0, 0x0
.long 0x0, 0x0, 0x0, 0x0
.long 0x0, 0x0, 0x0, 0x0
.long 0x0, 0x0, 0x0, 0x0
.long 0x0, 0x0, 0x0, 0x0
.long 0x3f80, 0x0, 0x0, 0x0
.long 0x3f803f80, 0x0, 0x0, 0x0
.long 0x3f803f80, 0x3f80, 0x0, 0x0
.long 0x0, 0x0, 0x3f803f80, 0x3f803f80
.long 0x0, 0x0, 0x3f800000, 0x3f803f80
.long 0x0, 0x0, 0x0, 0x3f803f80
.long 0x0, 0x0, 0x0, 0x3f800000
.long 0x0, 0x0, 0x0, 0x0
.long 0x0, 0x0, 0x0, 0x0
.long 0x0, 0x0, 0x0, 0x0
.long 0x0, 0x0, 0x0, 0x0
.long 0x0, 0x0, 0x0, 0x0
.long 0x0, 0x0, 0x0, 0x0
.long 0x0, 0x0, 0x0, 0x0
.long 0x0, 0x0, 0x0, 0x0
.long 0x0, 0x0, 0x0, 0x0
.long 0x0, 0x0, 0x0, 0x0
.long 0x0, 0x0, 0x0, 0x0
.long 0x0, 0x0, 0x0, 0x0
.long 0x3f803f80, 0x3f803f80, 0x3f80, 0x0
.long 0x3f803f80, 0x3f803f80, 0x3f803f80, 0x0
.long 0x3f803f80, 0x3f803f80, 0x3f803f80, 0x3f80
.long 0x3f803f80, 0x3f803f80, 0x3f803f80, 0x3f803f80
.long 0x3f803f80, 0x3f803f80, 0x3f803f80, 0x3f803f80
.long 0x3f800000, 0x3f803f80, 0x3f803f80, 0x3f803f80
.long 0x0, 0x3f803f80, 0x3f803f80, 0x3f803f80
.long 0x0, 0x3f800000, 0x3f803f80, 0x3f803f80
.long 0x0, 0x0, 0x3f803f80, 0x3f803f80
.long 0x0, 0x0, 0x3f800000, 0x3f803f80
.long 0x0, 0x0, 0x0, 0x3f803f80
.long 0x0, 0x0, 0x0, 0x3f800000
.long 0x0, 0x0, 0x0, 0x0
.long 0x0, 0x0, 0x0, 0x0
.long 0x0, 0x0, 0x0, 0x0
.long 0x0, 0x0, 0x0, 0x0
.long 0x0, 0x0, 0x0, 0x0
.long 0x0, 0x0, 0x0, 0x0
.long 0x0, 0x0, 0x0, 0x0
.long 0x0, 0x0, 0x0, 0x0
.long 0x3f80, 0x0, 0x0, 0x0
.long 0x3f803f80, 0x0, 0x0, 0x0
.long 0x3f803f80, 0x3f80, 0x0, 0x0
.long 0x3f803f80, 0x3f803f80, 0x0, 0x0
.long 0x3f803f80, 0x3f803f80, 0x3f80, 0x0
.long 0x3f803f80, 0x3f803f80, 0x3f803f80, 0x0
.long 0x3f803f80, 0x3f803f80, 0x3f803f80, 0x3f80
.long 0x3f803f80, 0x3f803f80, 0x3f803f80, 0x3f803f80
.long 0x3f803f80, 0x3f803f80, 0x3f803f80, 0x3f803f80
.long 0x3f800000, 0x3f803f80, 0x3f803f80, 0x3f803f80
.long 0x0, 0x3f803f80, 0x3f803f80, 0x3f803f80
.long 0x0, 0x3f800000, 0x3f803f80, 0x3f803f80
.long 0x0, 0x0, 0x0, 0x0
.long 0x0, 0x0, 0x0, 0x0
.long 0x0, 0x0, 0x0, 0x0
.long 0x0, 0x0, 0x0, 0x0
.long 0x0, 0x0, 0x0, 0x0
.long 0x0, 0x0, 0x0, 0x0
.long 0x0, 0x0, 0x0, 0x0
.long 0x0, 0x0, 0x0, 0x0
.long 0x0, 0x0, 0x0, 0x0
.long 0x0, 0x0, 0x0, 0x0
.long 0x0, 0x0, 0x0, 0x0
.long 0x0, 0x0, 0x0, 0x0
.long 0x3f80, 0x0, 0x0, 0x0
.long 0x3f803f80, 0x0, 0x0, 0x0
.long 0x3f803f80, 0x3f80, 0x0, 0x0
.long 0x3f803f80, 0x3f803f80, 0x0, 0x0
.long 0x0, 0x18c0, 0xd18, 0x0
.long 0x20, 0x1080, 0x4d8, 0x10
.long 0x40, 0x840, 0xd14, 0x40
.long 0x60, 0x0, 0x4d4, 0x50
.long 0x80, 0x18b8, 0xd10, 0x80
.long 0xa0, 0x1078, 0x4d0, 0x90
.long 0xc0, 0x838, 0xd0c, 0xc0
.long 0xe0, 0xfffffff8, 0x4cc, 0xd0
.long 0x100, 0x18b0, 0xd08, 0x100
.long 0x120, 0x1070, 0x4c8, 0x110
.long 0x140, 0x830, 0xd04, 0x140
.long 0x160, 0xfffffff0, 0x4c4, 0x150
.long 0x180, 0x18a8, 0xd00, 0x180
.long 0x1a0, 0x1068, 0x4c0, 0x190
.long 0x1c0, 0x828, 0xcfc, 0x1c0
.long 0x1e0, 0xffffffe8, 0x4bc, 0x1d0
.long 0x10, 0x18d0, 0xd20, 0x8
.long 0x30, 0x1090, 0x4e0, 0x18
.long 0x50, 0x850, 0xd1c, 0x48
.long 0x70, 0x10, 0x4dc, 0x58
.long 0x90, 0x18c8, 0xd18, 0x88
.long 0xb0, 0x1088, 0x4d8, 0x98
.long 0xd0, 0x848, 0xd14, 0xc8
.long 0xf0, 0x8, 0x4d4, 0xd8
.long 0x110, 0x18c0, 0xd10, 0x108
.long 0x130, 0x1080, 0x4d0, 0x118
.long 0x150, 0x840, 0xd0c, 0x148
.long 0x170, 0x0, 0x4cc, 0x158
.long 0x190, 0x18b8, 0xd08, 0x188
.long 0x1b0, 0x1078, 0x4c8, 0x198
.long 0x1d0, 0x838, 0xd04, 0x1c8
.long 0x1f0, 0xfffffff8, 0x4c4, 0x1d8
.long 0x20, 0x18e0, 0xd28, 0x200
.long 0x40, 0x10a0, 0x4e8, 0x210
.long 0x60, 0x860, 0xd24, 0x240
.long 0x80, 0x20, 0x4e4, 0x250
.long 0xa0, 0x18d8, 0xd20, 0x280
.long 0xc0, 0x1098, 0x4e0, 0x290
.long 0xe0, 0x858, 0xd1c, 0x2c0
.long 0x100, 0x18, 0x4dc, 0x2d0
.long 0x120, 0x18d0, 0xd18, 0x300
.long 0x140, 0x1090, 0x4d8, 0x310
.long 0x160, 0x850, 0xd14, 0x340
.long 0x180, 0x10, 0x4d4, 0x350
.long 0x1a0, 0x18c8, 0xd10, 0x380
.long 0x1c0, 0x1088, 0x4d0, 0x390
.long 0x1e0, 0x848, 0xd0c, 0x3c0
.long 0x200, 0x8, 0x4cc, 0x3d0
.long 0x30, 0x18f0, 0xd30, 0x208
.long 0x50, 0x10b0, 0x4f0, 0x218
.long 0x70, 0x870, 0xd2c, 0x248
.long 0x90, 0x30, 0x4ec, 0x258
.long 0xb0, 0x18e8, 0xd28, 0x288
.long 0xd0, 0x10a8, 0x4e8, 0x298
.long 0xf0, 0x868, 0xd24, 0x2c8
.long 0x110, 0x28, 0x4e4, 0x2d8
.long 0x130, 0x18e0, 0xd20, 0x308
.long 0x150, 0x10a0, 0x4e0, 0x318
.long 0x170, 0x860, 0xd1c, 0x348
.long 0x190, 0x20, 0x4dc, 0x358
.long 0x1b0, 0x18d8, 0xd18, 0x388
.long 0x1d0, 0x1098, 0x4d8, 0x398
.long 0x1f0, 0x858, 0xd14, 0x3c8
.long 0x210, 0x18, 0x4d4, 0x3d8
.long 0x0, 0x430, 0x0, 0x0
.long 0x10, 0x420, 0x0, 0x0
.long 0x20, 0x410, 0x0, 0x0
.long 0x30, 0x400, 0x0, 0x0
.long 0x40, 0x3f0, 0x0, 0x0
.long 0x50, 0x3e0, 0x0, 0x0
.long 0x60, 0x3d0, 0x0, 0x0
.long 0x70, 0x3c0, 0x0, 0x0
.long 0x80, 0x3b0, 0x0, 0x0
.long 0x90, 0x3a0, 0x0, 0x0
.long 0xa0, 0x390, 0x0, 0x0
.long 0xb0, 0x380, 0x0, 0x0
.long 0xc0, 0x370, 0x0, 0x0
.long 0xd0, 0x360, 0x0, 0x0
.long 0xe0, 0x350, 0x0, 0x0
.long 0xf0, 0x340, 0x0, 0x0
.long 0x100, 0x330, 0x0, 0x0
.long 0x110, 0x320, 0x0, 0x0
.long 0x120, 0x310, 0x0, 0x0
.long 0x130, 0x300, 0x0, 0x0
.long 0x140, 0x2f0, 0x0, 0x0
.long 0x150, 0x2e0, 0x0, 0x0
.long 0x160, 0x2d0, 0x0, 0x0
.long 0x170, 0x2c0, 0x0, 0x0
.long 0x180, 0x2b0, 0x0, 0x0
.long 0x190, 0x2a0, 0x0, 0x0
.long 0x1a0, 0x290, 0x0, 0x0
.long 0x1b0, 0x280, 0x0, 0x0
.long 0x1c0, 0x270, 0x0, 0x0
.long 0x1d0, 0x260, 0x0, 0x0
.long 0x1e0, 0x250, 0x0, 0x0
.long 0x1f0, 0x240, 0x0, 0x0
.long 0x200, 0x230, 0x0, 0x0
.long 0x210, 0x220, 0x0, 0x0
.long 0x220, 0x210, 0x0, 0x0
.long 0x230, 0x200, 0x0, 0x0
.long 0x240, 0x1f0, 0x0, 0x0
.long 0x250, 0x1e0, 0x0, 0x0
.long 0x260, 0x1d0, 0x0, 0x0
.long 0x270, 0x1c0, 0x0, 0x0
.long 0x280, 0x1b0, 0x0, 0x0
.long 0x290, 0x1a0, 0x0, 0x0
.long 0x2a0, 0x190, 0x0, 0x0
.long 0x2b0, 0x180, 0x0, 0x0
.long 0x2c0, 0x170, 0x0, 0x0
.long 0x2d0, 0x160, 0x0, 0x0
.long 0x2e0, 0x150, 0x0, 0x0
.long 0x2f0, 0x140, 0x0, 0x0
.long 0x300, 0x130, 0x0, 0x0
.long 0x310, 0x120, 0x0, 0x0
.long 0x320, 0x110, 0x0, 0x0
.long 0x330, 0x100, 0x0, 0x0
.long 0x340, 0xf0, 0x0, 0x0
.long 0x350, 0xe0, 0x0, 0x0
.long 0x360, 0xd0, 0x0, 0x0
.long 0x370, 0xc0, 0x0, 0x0
.long 0x380, 0xb0, 0x0, 0x0
.long 0x390, 0xa0, 0x0, 0x0
.long 0x3a0, 0x90, 0x0, 0x0
.long 0x3b0, 0x80, 0x0, 0x0
.long 0x3c0, 0x70, 0x0, 0x0
.long 0x3d0, 0x60, 0x0, 0x0
.long 0x3e0, 0x50, 0x0, 0x0
.long 0x3f0, 0x40, 0x0, 0x0
.long 0x0, 0x40, 0xedc, 0x69e
.long 0x10, 0x3e, 0x59c, 0xdda
.long 0x20, 0x3c, 0xed8, 0x69a
.long 0x30, 0x3a, 0x598, 0xdd6
.long 0x40, 0x820, 0xed4, 0x696
.long 0x50, 0x820, 0x594, 0xdd2
.long 0x60, 0x820, 0xed0, 0x692
.long 0x70, 0x820, 0x590, 0xdce
.long 0x80, 0x820, 0xecc, 0x68e
.long 0x90, 0x820, 0x58c, 0xdca
.long 0xa0, 0x820, 0xec8, 0x68a
.long 0xb0, 0x820, 0x588, 0xdc6
.long 0xc0, 0x820, 0xec4, 0x686
.long 0xd0, 0x820, 0x584, 0xdc2
.long 0xe0, 0x820, 0xec0, 0x682
.long 0xf0, 0x820, 0x580, 0xdbe
.long 0x100, 0x760, 0xebc, 0x67e
.long 0x110, 0x820, 0x57c, 0xdba
.long 0x120, 0x820, 0xeb8, 0x67a
.long 0x130, 0x820, 0x578, 0xdb6
.long 0x140, 0x820, 0xeb4, 0x676
.long 0x150, 0x820, 0x574, 0xdb2
.long 0x160, 0x820, 0xeb0, 0x672
.long 0x170, 0x820, 0x570, 0xdae
.long 0x180, 0x820, 0xeac, 0x66e
.long 0x190, 0x820, 0x56c, 0xdaa
.long 0x1a0, 0x820, 0xea8, 0x66a
.long 0x1b0, 0x820, 0x568, 0xda6
.long 0x1c0, 0x820, 0xea4, 0x666
.long 0x1d0, 0x820, 0x564, 0xda2
.long 0x1e0, 0x820, 0xea0, 0x662
.long 0x1f0, 0x820, 0x560, 0xd9e
.long 0x200, 0x498, 0x101c, 0x7de
.long 0x210, 0x496, 0x73c, 0xf7a
.long 0x220, 0x660, 0x1018, 0x7da
.long 0x230, 0x820, 0x738, 0xf76
.long 0x240, 0x820, 0x1014, 0x7d6
.long 0x250, 0x820, 0x734, 0xf72
.long 0x260, 0x820, 0x1010, 0x7d2
.long 0x270, 0x820, 0x730, 0xf6e
.long 0x280, 0x820, 0x100c, 0x7ce
.long 0x290, 0x820, 0x72c, 0xf6a
.long 0x2a0, 0x820, 0x1008, 0x7ca
.long 0x2b0, 0x820, 0x728, 0xf66
.long 0x2c0, 0x820, 0x1004, 0x7c6
.long 0x2d0, 0x820, 0x724, 0xf62
.long 0x2e0, 0x820, 0x1000, 0x7c2
.long 0x2f0, 0x820, 0x720, 0xf5e
.long 0x300, 0x44, 0xffc, 0x7be
.long 0x310, 0x820, 0x71c, 0xf5a
.long 0x320, 0x820, 0xff8, 0x7ba
.long 0x330, 0x820, 0x718, 0xf56
.long 0x340, 0x42, 0xff4, 0x7b6
.long 0x350, 0x820, 0x714, 0xf52
.long 0x360, 0x820, 0xff0, 0x7b2
.long 0x370, 0x820, 0x710, 0xf4e
.long 0x380, 0x820, 0xfec, 0x7ae
.long 0x390, 0x820, 0x70c, 0xf4a
.long 0x3a0, 0x820, 0xfe8, 0x7aa
.long 0x3b0, 0x820, 0x708, 0xf46
.long 0x3c0, 0x820, 0xfe4, 0x7a6
.long 0x3d0, 0x820, 0x704, 0xf42
.long 0x3e0, 0x820, 0xfe0, 0x7a2
.long 0x3f0, 0x820, 0x700, 0xf3e
.long 0x51c, 0xd5a, 0x0, 0x0
.long 0x61c, 0xe5a, 0x0, 0x0
.long 0x518, 0xd56, 0x0, 0x0
.long 0x618, 0xe56, 0x0, 0x0
.long 0x514, 0xd52, 0x0, 0x0
.long 0x614, 0xe52, 0x0, 0x0
.long 0x510, 0xd4e, 0x0, 0x0
.long 0x610, 0xe4e, 0x0, 0x0
.long 0x50c, 0xd4a, 0x0, 0x0
.long 0x60c, 0xe4a, 0x0, 0x0
.long 0x508, 0xd46, 0x0, 0x0
.long 0x608, 0xe46, 0x0, 0x0
.long 0x504, 0xd42, 0x0, 0x0
.long 0x604, 0xe42, 0x0, 0x0
.long 0x500, 0xd3e, 0x0, 0x0
.long 0x600, 0xe3e, 0x0, 0x0
.long 0x4fc, 0xd3a, 0x0, 0x0
.long 0x5fc, 0xe3a, 0x0, 0x0
.long 0x4f8, 0xd36, 0x0, 0x0
.long 0x5f8, 0xe36, 0x0, 0x0
.long 0x4f4, 0xd32, 0x0, 0x0
.long 0x5f4, 0xe32, 0x0, 0x0
.long 0x4f0, 0xd2e, 0x0, 0x0
.long 0x5f0, 0xe2e, 0x0, 0x0
.long 0x4ec, 0xd2a, 0x0, 0x0
.long 0x5ec, 0xe2a, 0x0, 0x0
.long 0x4e8, 0xd26, 0x0, 0x0
.long 0x5e8, 0xe26, 0x0, 0x0
.long 0x4e4, 0xd22, 0x0, 0x0
.long 0x5e4, 0xe22, 0x0, 0x0
.long 0x4e0, 0xd1e, 0x0, 0x0
.long 0x5e0, 0xe1e, 0x0, 0x0
.long 0xfdc, 0x79e, 0x0, 0x0
.long 0x6fc, 0xf3a, 0x0, 0x0
.long 0xfd8, 0x79a, 0x0, 0x0
.long 0x6f8, 0xf36, 0x0, 0x0
.long 0xfd4, 0x796, 0x0, 0x0
.long 0x6f4, 0xf32, 0x0, 0x0
.long 0xfd0, 0x792, 0x0, 0x0
.long 0x6f0, 0xf2e, 0x0, 0x0
.long 0xfcc, 0x78e, 0x0, 0x0
.long 0x6ec, 0xf2a, 0x0, 0x0
.long 0xfc8, 0x78a, 0x0, 0x0
.long 0x6e8, 0xf26, 0x0, 0x0
.long 0xfc4, 0x786, 0x0, 0x0
.long 0x6e4, 0xf22, 0x0, 0x0
.long 0xfc0, 0x782, 0x0, 0x0
.long 0x6e0, 0xf1e, 0x0, 0x0
.long 0xfbc, 0x77e, 0x0, 0x0
.long 0x6dc, 0xf1a, 0x0, 0x0
.long 0xfb8, 0x77a, 0x0, 0x0
.long 0x6d8, 0xf16, 0x0, 0x0
.long 0xfb4, 0x776, 0x0, 0x0
.long 0x6d4, 0xf12, 0x0, 0x0
.long 0xfb0, 0x772, 0x0, 0x0
.long 0x6d0, 0xf0e, 0x0, 0x0
.long 0xfac, 0x76e, 0x0, 0x0
.long 0x6cc, 0xf0a, 0x0, 0x0
.long 0xfa8, 0x76a, 0x0, 0x0
.long 0x6c8, 0xf06, 0x0, 0x0
.long 0xfa4, 0x766, 0x0, 0x0
.long 0x6c4, 0xf02, 0x0, 0x0
.long 0xfa0, 0x762, 0x0, 0x0
.long 0x6c0, 0xefe, 0x0, 0x0
.size L_table, 8192
.section .rodata,"a"
.p2align 6
.amdhsa_kernel concat_heads__ssm_conv_s4d__ssm_conv_s4d__prompt_kernel
  .amdhsa_next_free_vgpr 128
  .amdhsa_next_free_sgpr 102
  .amdhsa_accum_offset 128
  .amdhsa_group_segment_fixed_size 0
  .amdhsa_kernarg_size 136
  .amdhsa_user_sgpr_count 2
  .amdhsa_user_sgpr_kernarg_segment_ptr 1
  .amdhsa_system_sgpr_workgroup_id_x 1
.end_amdhsa_kernel
```
